```python
import torch

def _softmax(x, axis=-1):
    return torch.softmax(x, dim=axis)
def _gelu(x):
    return torch.nn.functional.gelu(x, approximate="tanh")
def _silu(x):
    return torch.nn.functional.silu(x)
def _sigmoid(x):
    return torch.sigmoid(x)
def _layernorm(x, axis=-1, eps=1e-5):
    m = x.mean(dim=axis, keepdim=True)
    v = x.var(dim=axis, keepdim=True, unbiased=False)
    return (x - m) / torch.sqrt(v + eps)
def _scatter_add(tgt, idx, src, axis=0):
    return tgt.clone().index_add_(axis, idx, src)
def _segment_sum(src, seg, n):
    out = torch.zeros((n,) + src.shape[1:], dtype=src.dtype)
    return out.index_add_(0, seg, src)
def _pad(x, pw):
    flat = tuple(v for pair in reversed(pw) for v in pair)
    return torch.nn.functional.pad(x, flat)

kernel_name = 'concat_heads__mha_block_cached__gqa_block_cached__near_ridge'

def setup_inputs():

    _w = (lambda a: (lambda t: t.to(torch.bfloat16) if t.is_floating_point() else t)(torch.as_tensor(a)))
    def _A_setup():
        B, Sq, D = 16, 48, 640
        H, Sk, Dh = 32, 48, 128
        return {
            "x": _w((lambda *s: torch.randn(*s, dtype=torch.bfloat16) * 0.8)(B, Sq, D)),
            "k_cache": _w((lambda *s: torch.randn(*s, dtype=torch.bfloat16) * 0.8)(B, H, Sk, Dh)),
            "v_cache": _w((lambda *s: torch.randn(*s, dtype=torch.bfloat16) * 0.05)(B, H, Sk, Dh)),
            "wq": _w((lambda *s: torch.randn(*s, dtype=torch.bfloat16) * 0.8)(D, H * Dh) * (D ** -0.5)),
            "wo": _w((lambda *s: torch.randn(*s, dtype=torch.bfloat16) * 0.05)(H * Dh, D) * ((H * Dh) ** -0.5)),
        }
    _A_in = _A_setup()

    def _B_setup():
        B, Sq, D = 16, 48, 640
        Hq, Hkv, Sk, Dh = 32, 32, 48, 128
        assert Hq % Hkv == 0, (Hq, Hkv)
        return {
            "x": _w((lambda *s: torch.randn(*s, dtype=torch.bfloat16) * 0.8)(B, Sq, D)),
            "k_cache": _w((lambda *s: torch.randn(*s, dtype=torch.bfloat16) * 0.8)(B, Hkv, Sk, Dh)),
            "v_cache": _w((lambda *s: torch.randn(*s, dtype=torch.bfloat16) * 0.05)(B, Hkv, Sk, Dh)),
            "wq": _w((lambda *s: torch.randn(*s, dtype=torch.bfloat16) * 0.8)(D, Hq * Dh) * (D ** -0.5)),
            "wo": _w((lambda *s: torch.randn(*s, dtype=torch.bfloat16) * 0.05)(Hq * Dh, D) * ((Hq * Dh) ** -0.5)),
        }
    _B_in = _B_setup()

    return {
        "A_x": _A_in["x"],
        "A_k_cache": _A_in["k_cache"],
        "A_v_cache": _A_in["v_cache"],
        "A_wq": _A_in["wq"],
        "A_wo": _A_in["wo"],
        "B_x": _B_in["x"],
        "B_k_cache": _B_in["k_cache"],
        "B_v_cache": _B_in["v_cache"],
        "B_wq": _B_in["wq"],
        "B_wo": _B_in["wo"],
    }

def reference(A_x, A_k_cache, A_v_cache, A_wq, A_wo, B_x, B_k_cache, B_v_cache, B_wq, B_wo):
    def _A_ref(x, k_cache, v_cache, wq, wo):
        B, Sq, D = x.shape
        H, Dh = 32, 128
        q = (lambda x, *d: x.permute(*d))((x @ wq).reshape(B, Sq, H, Dh), 0, 2, 1, 3)
        scores = torch.einsum("bhqd,bhkd->bhqk", q, k_cache) * (Dh ** -0.5)
        p = _softmax(scores, axis=-1)
        o = torch.einsum("bhqk,bhkd->bhqd", p, v_cache)
        return (lambda x, *d: x.permute(*d))(o, 0, 2, 1, 3).reshape(B, Sq, H * Dh) @ wo

    def _B_ref(x, k_cache, v_cache, wq, wo):
        B, Sq, D = x.shape
        Hq, Dh = 32, 128
        Hkv = k_cache.shape[1]
        rep = Hq // Hkv
        q = (lambda x, *d: x.permute(*d))((x @ wq).reshape(B, Sq, Hq, Dh), 0, 2, 1, 3)
        k = (lambda x, n, axis: torch.repeat_interleave(x, n, dim=axis))(k_cache, rep, axis=1)
        v = (lambda x, n, axis: torch.repeat_interleave(x, n, dim=axis))(v_cache, rep, axis=1)
        scores = torch.einsum("bhqd,bhkd->bhqk", q, k) * (Dh ** -0.5)
        p = _softmax(scores, axis=-1)
        o = torch.einsum("bhqk,bhkd->bhqd", p, v)
        return (lambda x, *d: x.permute(*d))(o, 0, 2, 1, 3).reshape(B, Sq, Hq * Dh) @ wo

    a = _A_ref(A_x, A_k_cache, A_v_cache, A_wq, A_wo)
    b = _B_ref(B_x, B_k_cache, B_v_cache, B_wq, B_wo)
    return torch.concatenate([a, b], axis=-1)
```

```asm
; @launch kernel=k1_kernel grid=(256,1,1) block=(512,1,1) lds=163840
; @launch kernel=k2_kernel grid=(240,1,1) block=(512,1,1) lds=163840
.amdgcn_target "amdgcn-amd-amdhsa--gfx950"
.text
.globl k1_kernel
.p2align 8
.type k1_kernel,@function
k1_kernel:
    s_cmp_ge_u32 s2, 256
    s_cbranch_scc1 L_end_k1
    s_load_dwordx16 s[16:31], s[0:1], 0
    s_load_dwordx8 s[32:39], s[0:1], 64
    s_load_dwordx2 s[14:15], s[0:1], 96
    v_and_b32 v1, 63, v0
    v_lshrrev_b32 v7, 6, v0
    v_lshrrev_b32 v2, 4, v1
    v_readfirstlane_b32 s79, v7
    v_and_b32 v3, 15, v0
    v_bfe_u32 v4, v0, 2, 2
    v_and_b32 v5, 3, v0
    v_lshlrev_b32 v10, 4, v1
    s_and_b32 s3, s79, 3
    s_and_b32 s4, s2, 7
    s_lshr_b32 s5, s2, 3
    s_lshr_b32 s6, s4, 2
    s_and_b32 s7, s4, 3
    s_lshr_b32 s8, s5, 2
    s_and_b32 s9, s5, 3
    s_waitcnt lgkmcnt(0)
    s_cmp_eq_u32 s6, 0
    s_cselect_b32 s40, s16, s26
    s_cselect_b32 s41, s17, s27
    s_mov_b32 s42, 983040
    s_mov_b32 s43, 0x20000
    s_cselect_b32 s44, s18, s28
    s_cselect_b32 s45, s19, s29
    s_mov_b32 s46, 6291456
    s_mov_b32 s47, 0x20000
    s_cselect_b32 s48, s20, s30
    s_cselect_b32 s49, s21, s31
    s_mov_b32 s50, 6291456
    s_mov_b32 s51, 0x20000
    s_cselect_b32 s52, s22, s32
    s_cselect_b32 s53, s23, s33
    s_mov_b32 s54, 5242880
    s_mov_b32 s55, 0x20000
    s_cselect_b32 s60, s24, s34
    s_cselect_b32 s61, s25, s35
    s_mov_b32 s62, 5242880
    s_mov_b32 s63, 0x20000
    s_mov_b32 s56, s14
    s_mov_b32 s57, s15
    s_mov_b32 s58, 268435456
    s_mov_b32 s59, 0x20000
    s_lshl_b32 s16, s7, 3
    s_add_u32 s16, s16, s8
    s_lshl_b32 s17, s9, 1
    s_lshr_b32 s10, s8, 2
    s_add_u32 s17, s17, s10
    s_and_b32 s18, s8, 3
    s_cmp_ge_u32 s79, 4
    s_cbranch_scc1 L_loader_k1
    s_getpc_b64 s[30:31]
L_pc0:
    s_mov_b32 s10, (L_code_end - L_pc0 - 4)
    v_lshlrev_b32 v232, 7, v1
    s_lshl_b32 s11, s3, 13
    v_add_u32 v232, s11, v232
    v_add_u32 v233, 0, v232
    v_min_u32 v233, s10, v233
    global_load_dword v234, v233, s[30:31]
    v_add_u32 v233, 32768, v232
    v_min_u32 v233, s10, v233
    global_load_dword v235, v233, s[30:31]
    s_mul_i32 s10, s3, 24576
    s_add_u32 s77, s10, 65536
    s_lshl_b32 s22, s9, 2
    s_add_u32 s22, s22, s3
    v_and_b32 v7, 1, v2
    v_lshlrev_b32 v7, 2, v7
    v_or_b32 v6, v4, v7
    v_lshrrev_b32 v7, 1, v3
    v_xor_b32 v7, v7, v2
    v_lshlrev_b32 v8, 7, v3
    v_add_u32 v8, s77, v8
    v_lshl_add_u32 v11, v7, 4, v8
    v_xor_b32 v7, 4, v7
    v_lshl_add_u32 v12, v7, 4, v8
    v_lshl_add_u32 v7, v2, 3, v4
    v_lshlrev_b32 v7, 8, v7
    v_lshl_add_u32 v7, v5, 3, v7
    v_lshl_add_u32 v8, v2, 2, v4
    v_lshlrev_b32 v8, 8, v8
    v_lshl_add_u32 v8, v5, 3, v8
    v_add_u32 v8, s77, v8
    v_xor_b32 v232, 0, v6
    v_lshl_add_u32 v13, v232, 5, v7
    v_lshl_add_u32 v21, v232, 5, v8
    v_xor_b32 v232, 1, v6
    v_lshl_add_u32 v14, v232, 5, v7
    v_lshl_add_u32 v22, v232, 5, v8
    v_xor_b32 v232, 2, v6
    v_lshl_add_u32 v15, v232, 5, v7
    v_lshl_add_u32 v23, v232, 5, v8
    v_xor_b32 v232, 3, v6
    v_lshl_add_u32 v16, v232, 5, v7
    v_lshl_add_u32 v24, v232, 5, v8
    v_xor_b32 v232, 4, v6
    v_lshl_add_u32 v17, v232, 5, v7
    v_lshl_add_u32 v25, v232, 5, v8
    v_xor_b32 v232, 5, v6
    v_lshl_add_u32 v18, v232, 5, v7
    v_lshl_add_u32 v26, v232, 5, v8
    v_xor_b32 v232, 6, v6
    v_lshl_add_u32 v19, v232, 5, v7
    v_lshl_add_u32 v27, v232, 5, v8
    v_xor_b32 v232, 7, v6
    v_lshl_add_u32 v20, v232, 5, v7
    v_lshl_add_u32 v28, v232, 5, v8
    v_lshrrev_b32 v7, 1, v2
    v_xor_b32 v7, v7, v3
    v_and_b32 v8, 1, v2
    v_lshlrev_b32 v8, 3, v8
    v_lshl_add_u32 v8, v3, 8, v8
    v_add_u32 v8, s77, v8
    v_xor_b32 v232, 0, v7
    v_lshl_add_u32 v29, v232, 4, v8
    v_xor_b32 v232, 2, v7
    v_lshl_add_u32 v30, v232, 4, v8
    v_xor_b32 v232, 4, v7
    v_lshl_add_u32 v31, v232, 4, v8
    v_xor_b32 v232, 6, v7
    v_lshl_add_u32 v32, v232, 4, v8
    v_xor_b32 v232, 8, v7
    v_lshl_add_u32 v33, v232, 4, v8
    v_xor_b32 v232, 10, v7
    v_lshl_add_u32 v34, v232, 4, v8
    v_xor_b32 v232, 12, v7
    v_lshl_add_u32 v35, v232, 4, v8
    v_xor_b32 v232, 14, v7
    v_lshl_add_u32 v36, v232, 4, v8
    s_mul_i32 s10, s6, 48
    s_mul_i32 s11, s22, 3
    s_add_u32 s10, s10, s11
    s_lshl_b32 s10, s10, 7
    s_lshl_b32 s11, s16, 2
    s_add_u32 s10, s10, s11
    s_lshl_b32 s24, s10, 10
    s_add_u32 s25, s24, 131072
    s_add_u32 s26, s24, 262144
    s_mov_b32 s98, 1040356334
    s_barrier
    ds_read_b128 v[72:75], v11 offset:0
    ds_read_b128 v[76:79], v11 offset:2048
    ds_read_b128 v[80:83], v11 offset:4096
    ds_read_b64_tr_b16 v[40:41], v13 offset:0
    ds_read_b64_tr_b16 v[42:43], v13 offset:1024
    ds_read_b64_tr_b16 v[44:45], v14 offset:0
    ds_read_b64_tr_b16 v[46:47], v14 offset:1024
    ds_read_b64_tr_b16 v[48:49], v15 offset:0
    ds_read_b64_tr_b16 v[50:51], v15 offset:1024
    ds_read_b64_tr_b16 v[52:53], v16 offset:0
    ds_read_b64_tr_b16 v[54:55], v16 offset:1024
    ds_read_b64_tr_b16 v[56:57], v17 offset:0
    ds_read_b64_tr_b16 v[58:59], v17 offset:1024
    ds_read_b64_tr_b16 v[60:61], v18 offset:0
    ds_read_b64_tr_b16 v[62:63], v18 offset:1024
    ds_read_b64_tr_b16 v[64:65], v19 offset:0
    ds_read_b64_tr_b16 v[66:67], v19 offset:1024
    ds_read_b64_tr_b16 v[68:69], v20 offset:0
    ds_read_b64_tr_b16 v[70:71], v20 offset:1024
    s_waitcnt lgkmcnt(14)
    v_mfma_f32_16x16x32_bf16 v[136:139], v[40:43], v[72:75], 0
    ds_read_b128 v[116:119], v12 offset:0
    v_mfma_f32_16x16x32_bf16 v[140:143], v[40:43], v[76:79], 0
    ds_read_b128 v[120:123], v12 offset:2048
    v_mfma_f32_16x16x32_bf16 v[144:147], v[40:43], v[80:83], 0
    ds_read_b128 v[124:127], v12 offset:4096
    s_waitcnt lgkmcnt(15)
    v_mfma_f32_16x16x32_bf16 v[148:151], v[44:47], v[72:75], 0
    ds_read_b64_tr_b16 v[84:85], v13 offset:8192
    v_mfma_f32_16x16x32_bf16 v[152:155], v[44:47], v[76:79], 0
    ds_read_b64_tr_b16 v[86:87], v13 offset:9216
    v_mfma_f32_16x16x32_bf16 v[156:159], v[44:47], v[80:83], 0
    ds_read_b64_tr_b16 v[88:89], v14 offset:8192
    s_waitcnt lgkmcnt(15)
    v_mfma_f32_16x16x32_bf16 v[160:163], v[48:51], v[72:75], 0
    ds_read_b64_tr_b16 v[90:91], v14 offset:9216
    v_mfma_f32_16x16x32_bf16 v[164:167], v[48:51], v[76:79], 0
    ds_read_b64_tr_b16 v[92:93], v15 offset:8192
    v_mfma_f32_16x16x32_bf16 v[168:171], v[48:51], v[80:83], 0
    ds_read_b64_tr_b16 v[94:95], v15 offset:9216
    s_waitcnt lgkmcnt(15)
    v_mfma_f32_16x16x32_bf16 v[172:175], v[52:55], v[72:75], 0
    ds_read_b64_tr_b16 v[96:97], v16 offset:8192
    v_mfma_f32_16x16x32_bf16 v[176:179], v[52:55], v[76:79], 0
    ds_read_b64_tr_b16 v[98:99], v16 offset:9216
    v_mfma_f32_16x16x32_bf16 v[180:183], v[52:55], v[80:83], 0
    ds_read_b64_tr_b16 v[100:101], v17 offset:8192
    v_mfma_f32_16x16x32_bf16 v[184:187], v[56:59], v[72:75], 0
    ds_read_b64_tr_b16 v[102:103], v17 offset:9216
    v_mfma_f32_16x16x32_bf16 v[188:191], v[56:59], v[76:79], 0
    ds_read_b64_tr_b16 v[104:105], v18 offset:8192
    v_mfma_f32_16x16x32_bf16 v[192:195], v[56:59], v[80:83], 0
    ds_read_b64_tr_b16 v[106:107], v18 offset:9216
    s_waitcnt lgkmcnt(15)
    v_mfma_f32_16x16x32_bf16 v[196:199], v[60:63], v[72:75], 0
    ds_read_b64_tr_b16 v[108:109], v19 offset:8192
    v_mfma_f32_16x16x32_bf16 v[200:203], v[60:63], v[76:79], 0
    ds_read_b64_tr_b16 v[110:111], v19 offset:9216
    v_mfma_f32_16x16x32_bf16 v[204:207], v[60:63], v[80:83], 0
    ds_read_b64_tr_b16 v[112:113], v20 offset:8192
    v_mfma_f32_16x16x32_bf16 v[208:211], v[64:67], v[72:75], 0
    ds_read_b64_tr_b16 v[114:115], v20 offset:9216
    v_mfma_f32_16x16x32_bf16 v[212:215], v[64:67], v[76:79], 0
    v_mfma_f32_16x16x32_bf16 v[216:219], v[64:67], v[80:83], 0
    v_mfma_f32_16x16x32_bf16 v[220:223], v[68:71], v[72:75], 0
    v_mfma_f32_16x16x32_bf16 v[224:227], v[68:71], v[76:79], 0
    v_mfma_f32_16x16x32_bf16 v[228:231], v[68:71], v[80:83], 0
    s_waitcnt lgkmcnt(0)
    s_barrier
    v_mfma_f32_16x16x32_bf16 v[136:139], v[84:87], v[116:119], v[136:139]
    ds_read_b128 v[72:75], v11 offset:6144
    v_mfma_f32_16x16x32_bf16 v[140:143], v[84:87], v[120:123], v[140:143]
    ds_read_b128 v[76:79], v11 offset:8192
    v_mfma_f32_16x16x32_bf16 v[144:147], v[84:87], v[124:127], v[144:147]
    ds_read_b128 v[80:83], v11 offset:10240
    v_mfma_f32_16x16x32_bf16 v[148:151], v[88:91], v[116:119], v[148:151]
    ds_read_b64_tr_b16 v[40:41], v13 offset:16384
    v_mfma_f32_16x16x32_bf16 v[152:155], v[88:91], v[120:123], v[152:155]
    ds_read_b64_tr_b16 v[42:43], v13 offset:17408
    v_mfma_f32_16x16x32_bf16 v[156:159], v[88:91], v[124:127], v[156:159]
    ds_read_b64_tr_b16 v[44:45], v14 offset:16384
    v_mfma_f32_16x16x32_bf16 v[160:163], v[92:95], v[116:119], v[160:163]
    ds_read_b64_tr_b16 v[46:47], v14 offset:17408
    v_mfma_f32_16x16x32_bf16 v[164:167], v[92:95], v[120:123], v[164:167]
    ds_read_b64_tr_b16 v[48:49], v15 offset:16384
    v_mfma_f32_16x16x32_bf16 v[168:171], v[92:95], v[124:127], v[168:171]
    ds_read_b64_tr_b16 v[50:51], v15 offset:17408
    v_mfma_f32_16x16x32_bf16 v[172:175], v[96:99], v[116:119], v[172:175]
    ds_read_b64_tr_b16 v[52:53], v16 offset:16384
    v_mfma_f32_16x16x32_bf16 v[176:179], v[96:99], v[120:123], v[176:179]
    ds_read_b64_tr_b16 v[54:55], v16 offset:17408
    v_mfma_f32_16x16x32_bf16 v[180:183], v[96:99], v[124:127], v[180:183]
    ds_read_b64_tr_b16 v[56:57], v17 offset:16384
    v_mfma_f32_16x16x32_bf16 v[184:187], v[100:103], v[116:119], v[184:187]
    ds_read_b64_tr_b16 v[58:59], v17 offset:17408
    v_mfma_f32_16x16x32_bf16 v[188:191], v[100:103], v[120:123], v[188:191]
    ds_read_b64_tr_b16 v[60:61], v18 offset:16384
    v_mfma_f32_16x16x32_bf16 v[192:195], v[100:103], v[124:127], v[192:195]
    ds_read_b64_tr_b16 v[62:63], v18 offset:17408
    v_mfma_f32_16x16x32_bf16 v[196:199], v[104:107], v[116:119], v[196:199]
    ds_read_b64_tr_b16 v[64:65], v19 offset:16384
    v_mfma_f32_16x16x32_bf16 v[200:203], v[104:107], v[120:123], v[200:203]
    ds_read_b64_tr_b16 v[66:67], v19 offset:17408
    v_mfma_f32_16x16x32_bf16 v[204:207], v[104:107], v[124:127], v[204:207]
    ds_read_b64_tr_b16 v[68:69], v20 offset:16384
    v_mfma_f32_16x16x32_bf16 v[208:211], v[108:111], v[116:119], v[208:211]
    ds_read_b64_tr_b16 v[70:71], v20 offset:17408
    v_mfma_f32_16x16x32_bf16 v[212:215], v[108:111], v[120:123], v[212:215]
    v_mfma_f32_16x16x32_bf16 v[216:219], v[108:111], v[124:127], v[216:219]
    v_mfma_f32_16x16x32_bf16 v[220:223], v[112:115], v[116:119], v[220:223]
    v_mfma_f32_16x16x32_bf16 v[224:227], v[112:115], v[120:123], v[224:227]
    v_mfma_f32_16x16x32_bf16 v[228:231], v[112:115], v[124:127], v[228:231]
    s_waitcnt lgkmcnt(14)
    v_mfma_f32_16x16x32_bf16 v[136:139], v[40:43], v[72:75], v[136:139]
    ds_read_b128 v[116:119], v12 offset:6144
    v_mfma_f32_16x16x32_bf16 v[140:143], v[40:43], v[76:79], v[140:143]
    ds_read_b128 v[120:123], v12 offset:8192
    v_mfma_f32_16x16x32_bf16 v[144:147], v[40:43], v[80:83], v[144:147]
    ds_read_b128 v[124:127], v12 offset:10240
    s_waitcnt lgkmcnt(15)
    v_mfma_f32_16x16x32_bf16 v[148:151], v[44:47], v[72:75], v[148:151]
    ds_read_b64_tr_b16 v[84:85], v13 offset:24576
    v_mfma_f32_16x16x32_bf16 v[152:155], v[44:47], v[76:79], v[152:155]
    ds_read_b64_tr_b16 v[86:87], v13 offset:25600
    v_mfma_f32_16x16x32_bf16 v[156:159], v[44:47], v[80:83], v[156:159]
    ds_read_b64_tr_b16 v[88:89], v14 offset:24576
    s_waitcnt lgkmcnt(15)
    v_mfma_f32_16x16x32_bf16 v[160:163], v[48:51], v[72:75], v[160:163]
    ds_read_b64_tr_b16 v[90:91], v14 offset:25600
    v_mfma_f32_16x16x32_bf16 v[164:167], v[48:51], v[76:79], v[164:167]
    ds_read_b64_tr_b16 v[92:93], v15 offset:24576
    v_mfma_f32_16x16x32_bf16 v[168:171], v[48:51], v[80:83], v[168:171]
    ds_read_b64_tr_b16 v[94:95], v15 offset:25600
    s_waitcnt lgkmcnt(15)
    v_mfma_f32_16x16x32_bf16 v[172:175], v[52:55], v[72:75], v[172:175]
    ds_read_b64_tr_b16 v[96:97], v16 offset:24576
    v_mfma_f32_16x16x32_bf16 v[176:179], v[52:55], v[76:79], v[176:179]
    ds_read_b64_tr_b16 v[98:99], v16 offset:25600
    v_mfma_f32_16x16x32_bf16 v[180:183], v[52:55], v[80:83], v[180:183]
    ds_read_b64_tr_b16 v[100:101], v17 offset:24576
    v_mfma_f32_16x16x32_bf16 v[184:187], v[56:59], v[72:75], v[184:187]
    ds_read_b64_tr_b16 v[102:103], v17 offset:25600
    v_mfma_f32_16x16x32_bf16 v[188:191], v[56:59], v[76:79], v[188:191]
    ds_read_b64_tr_b16 v[104:105], v18 offset:24576
    v_mfma_f32_16x16x32_bf16 v[192:195], v[56:59], v[80:83], v[192:195]
    ds_read_b64_tr_b16 v[106:107], v18 offset:25600
    s_waitcnt lgkmcnt(15)
    v_mfma_f32_16x16x32_bf16 v[196:199], v[60:63], v[72:75], v[196:199]
    ds_read_b64_tr_b16 v[108:109], v19 offset:24576
    v_mfma_f32_16x16x32_bf16 v[200:203], v[60:63], v[76:79], v[200:203]
    ds_read_b64_tr_b16 v[110:111], v19 offset:25600
    v_mfma_f32_16x16x32_bf16 v[204:207], v[60:63], v[80:83], v[204:207]
    ds_read_b64_tr_b16 v[112:113], v20 offset:24576
    v_mfma_f32_16x16x32_bf16 v[208:211], v[64:67], v[72:75], v[208:211]
    ds_read_b64_tr_b16 v[114:115], v20 offset:25600
    v_mfma_f32_16x16x32_bf16 v[212:215], v[64:67], v[76:79], v[212:215]
    v_mfma_f32_16x16x32_bf16 v[216:219], v[64:67], v[80:83], v[216:219]
    v_mfma_f32_16x16x32_bf16 v[220:223], v[68:71], v[72:75], v[220:223]
    v_mfma_f32_16x16x32_bf16 v[224:227], v[68:71], v[76:79], v[224:227]
    v_mfma_f32_16x16x32_bf16 v[228:231], v[68:71], v[80:83], v[228:231]
    s_waitcnt lgkmcnt(0)
    s_barrier
    v_mfma_f32_16x16x32_bf16 v[136:139], v[84:87], v[116:119], v[136:139]
    ds_read_b128 v[72:75], v11 offset:12288
    v_mfma_f32_16x16x32_bf16 v[140:143], v[84:87], v[120:123], v[140:143]
    ds_read_b128 v[76:79], v11 offset:14336
    v_mfma_f32_16x16x32_bf16 v[144:147], v[84:87], v[124:127], v[144:147]
    ds_read_b128 v[80:83], v11 offset:16384
    v_mfma_f32_16x16x32_bf16 v[148:151], v[88:91], v[116:119], v[148:151]
    ds_read_b64_tr_b16 v[40:41], v13 offset:32768
    v_mfma_f32_16x16x32_bf16 v[152:155], v[88:91], v[120:123], v[152:155]
    ds_read_b64_tr_b16 v[42:43], v13 offset:33792
    v_mfma_f32_16x16x32_bf16 v[156:159], v[88:91], v[124:127], v[156:159]
    ds_read_b64_tr_b16 v[44:45], v14 offset:32768
    v_mfma_f32_16x16x32_bf16 v[160:163], v[92:95], v[116:119], v[160:163]
    ds_read_b64_tr_b16 v[46:47], v14 offset:33792
    v_mfma_f32_16x16x32_bf16 v[164:167], v[92:95], v[120:123], v[164:167]
    ds_read_b64_tr_b16 v[48:49], v15 offset:32768
    v_mfma_f32_16x16x32_bf16 v[168:171], v[92:95], v[124:127], v[168:171]
    ds_read_b64_tr_b16 v[50:51], v15 offset:33792
    v_mfma_f32_16x16x32_bf16 v[172:175], v[96:99], v[116:119], v[172:175]
    ds_read_b64_tr_b16 v[52:53], v16 offset:32768
    v_mfma_f32_16x16x32_bf16 v[176:179], v[96:99], v[120:123], v[176:179]
    ds_read_b64_tr_b16 v[54:55], v16 offset:33792
    v_mfma_f32_16x16x32_bf16 v[180:183], v[96:99], v[124:127], v[180:183]
    ds_read_b64_tr_b16 v[56:57], v17 offset:32768
    v_mfma_f32_16x16x32_bf16 v[184:187], v[100:103], v[116:119], v[184:187]
    ds_read_b64_tr_b16 v[58:59], v17 offset:33792
    v_mfma_f32_16x16x32_bf16 v[188:191], v[100:103], v[120:123], v[188:191]
    ds_read_b64_tr_b16 v[60:61], v18 offset:32768
    v_mfma_f32_16x16x32_bf16 v[192:195], v[100:103], v[124:127], v[192:195]
    ds_read_b64_tr_b16 v[62:63], v18 offset:33792
    v_mfma_f32_16x16x32_bf16 v[196:199], v[104:107], v[116:119], v[196:199]
    ds_read_b64_tr_b16 v[64:65], v19 offset:32768
    v_mfma_f32_16x16x32_bf16 v[200:203], v[104:107], v[120:123], v[200:203]
    ds_read_b64_tr_b16 v[66:67], v19 offset:33792
    v_mfma_f32_16x16x32_bf16 v[204:207], v[104:107], v[124:127], v[204:207]
    ds_read_b64_tr_b16 v[68:69], v20 offset:32768
    v_mfma_f32_16x16x32_bf16 v[208:211], v[108:111], v[116:119], v[208:211]
    ds_read_b64_tr_b16 v[70:71], v20 offset:33792
    v_mfma_f32_16x16x32_bf16 v[212:215], v[108:111], v[120:123], v[212:215]
    v_mfma_f32_16x16x32_bf16 v[216:219], v[108:111], v[124:127], v[216:219]
    v_mfma_f32_16x16x32_bf16 v[220:223], v[112:115], v[116:119], v[220:223]
    v_mfma_f32_16x16x32_bf16 v[224:227], v[112:115], v[120:123], v[224:227]
    v_mfma_f32_16x16x32_bf16 v[228:231], v[112:115], v[124:127], v[228:231]
    s_waitcnt lgkmcnt(14)
    v_mfma_f32_16x16x32_bf16 v[136:139], v[40:43], v[72:75], v[136:139]
    ds_read_b128 v[116:119], v12 offset:12288
    v_mfma_f32_16x16x32_bf16 v[140:143], v[40:43], v[76:79], v[140:143]
    ds_read_b128 v[120:123], v12 offset:14336
    v_mfma_f32_16x16x32_bf16 v[144:147], v[40:43], v[80:83], v[144:147]
    ds_read_b128 v[124:127], v12 offset:16384
    s_waitcnt lgkmcnt(15)
    v_mfma_f32_16x16x32_bf16 v[148:151], v[44:47], v[72:75], v[148:151]
    ds_read_b64_tr_b16 v[84:85], v13 offset:40960
    v_mfma_f32_16x16x32_bf16 v[152:155], v[44:47], v[76:79], v[152:155]
    ds_read_b64_tr_b16 v[86:87], v13 offset:41984
    v_mfma_f32_16x16x32_bf16 v[156:159], v[44:47], v[80:83], v[156:159]
    ds_read_b64_tr_b16 v[88:89], v14 offset:40960
    s_waitcnt lgkmcnt(15)
    v_mfma_f32_16x16x32_bf16 v[160:163], v[48:51], v[72:75], v[160:163]
    ds_read_b64_tr_b16 v[90:91], v14 offset:41984
    v_mfma_f32_16x16x32_bf16 v[164:167], v[48:51], v[76:79], v[164:167]
    ds_read_b64_tr_b16 v[92:93], v15 offset:40960
    v_mfma_f32_16x16x32_bf16 v[168:171], v[48:51], v[80:83], v[168:171]
    ds_read_b64_tr_b16 v[94:95], v15 offset:41984
    s_waitcnt lgkmcnt(15)
    v_mfma_f32_16x16x32_bf16 v[172:175], v[52:55], v[72:75], v[172:175]
    ds_read_b64_tr_b16 v[96:97], v16 offset:40960
    v_mfma_f32_16x16x32_bf16 v[176:179], v[52:55], v[76:79], v[176:179]
    ds_read_b64_tr_b16 v[98:99], v16 offset:41984
    v_mfma_f32_16x16x32_bf16 v[180:183], v[52:55], v[80:83], v[180:183]
    ds_read_b64_tr_b16 v[100:101], v17 offset:40960
    v_mfma_f32_16x16x32_bf16 v[184:187], v[56:59], v[72:75], v[184:187]
    ds_read_b64_tr_b16 v[102:103], v17 offset:41984
    v_mfma_f32_16x16x32_bf16 v[188:191], v[56:59], v[76:79], v[188:191]
    ds_read_b64_tr_b16 v[104:105], v18 offset:40960
    v_mfma_f32_16x16x32_bf16 v[192:195], v[56:59], v[80:83], v[192:195]
    ds_read_b64_tr_b16 v[106:107], v18 offset:41984
    s_waitcnt lgkmcnt(15)
    v_mfma_f32_16x16x32_bf16 v[196:199], v[60:63], v[72:75], v[196:199]
    ds_read_b64_tr_b16 v[108:109], v19 offset:40960
    v_mfma_f32_16x16x32_bf16 v[200:203], v[60:63], v[76:79], v[200:203]
    ds_read_b64_tr_b16 v[110:111], v19 offset:41984
    v_mfma_f32_16x16x32_bf16 v[204:207], v[60:63], v[80:83], v[204:207]
    ds_read_b64_tr_b16 v[112:113], v20 offset:40960
    v_mfma_f32_16x16x32_bf16 v[208:211], v[64:67], v[72:75], v[208:211]
    ds_read_b64_tr_b16 v[114:115], v20 offset:41984
    v_mfma_f32_16x16x32_bf16 v[212:215], v[64:67], v[76:79], v[212:215]
    v_mfma_f32_16x16x32_bf16 v[216:219], v[64:67], v[80:83], v[216:219]
    v_mfma_f32_16x16x32_bf16 v[220:223], v[68:71], v[72:75], v[220:223]
    v_mfma_f32_16x16x32_bf16 v[224:227], v[68:71], v[76:79], v[224:227]
    v_mfma_f32_16x16x32_bf16 v[228:231], v[68:71], v[80:83], v[228:231]
    s_waitcnt lgkmcnt(0)
    s_barrier
    v_mfma_f32_16x16x32_bf16 v[136:139], v[84:87], v[116:119], v[136:139]
    ds_read_b128 v[72:75], v11 offset:18432
    v_mfma_f32_16x16x32_bf16 v[140:143], v[84:87], v[120:123], v[140:143]
    ds_read_b128 v[76:79], v11 offset:20480
    v_mfma_f32_16x16x32_bf16 v[144:147], v[84:87], v[124:127], v[144:147]
    ds_read_b128 v[80:83], v11 offset:22528
    v_mfma_f32_16x16x32_bf16 v[148:151], v[88:91], v[116:119], v[148:151]
    ds_read_b64_tr_b16 v[40:41], v13 offset:49152
    v_mfma_f32_16x16x32_bf16 v[152:155], v[88:91], v[120:123], v[152:155]
    ds_read_b64_tr_b16 v[42:43], v13 offset:50176
    v_mfma_f32_16x16x32_bf16 v[156:159], v[88:91], v[124:127], v[156:159]
    ds_read_b64_tr_b16 v[44:45], v14 offset:49152
    v_mfma_f32_16x16x32_bf16 v[160:163], v[92:95], v[116:119], v[160:163]
    ds_read_b64_tr_b16 v[46:47], v14 offset:50176
    v_mfma_f32_16x16x32_bf16 v[164:167], v[92:95], v[120:123], v[164:167]
    ds_read_b64_tr_b16 v[48:49], v15 offset:49152
    v_mfma_f32_16x16x32_bf16 v[168:171], v[92:95], v[124:127], v[168:171]
    ds_read_b64_tr_b16 v[50:51], v15 offset:50176
    v_mfma_f32_16x16x32_bf16 v[172:175], v[96:99], v[116:119], v[172:175]
    ds_read_b64_tr_b16 v[52:53], v16 offset:49152
    v_mfma_f32_16x16x32_bf16 v[176:179], v[96:99], v[120:123], v[176:179]
    ds_read_b64_tr_b16 v[54:55], v16 offset:50176
    v_mfma_f32_16x16x32_bf16 v[180:183], v[96:99], v[124:127], v[180:183]
    ds_read_b64_tr_b16 v[56:57], v17 offset:49152
    v_mfma_f32_16x16x32_bf16 v[184:187], v[100:103], v[116:119], v[184:187]
    ds_read_b64_tr_b16 v[58:59], v17 offset:50176
    v_mfma_f32_16x16x32_bf16 v[188:191], v[100:103], v[120:123], v[188:191]
    ds_read_b64_tr_b16 v[60:61], v18 offset:49152
    v_mfma_f32_16x16x32_bf16 v[192:195], v[100:103], v[124:127], v[192:195]
    ds_read_b64_tr_b16 v[62:63], v18 offset:50176
    v_mfma_f32_16x16x32_bf16 v[196:199], v[104:107], v[116:119], v[196:199]
    ds_read_b64_tr_b16 v[64:65], v19 offset:49152
    v_mfma_f32_16x16x32_bf16 v[200:203], v[104:107], v[120:123], v[200:203]
    ds_read_b64_tr_b16 v[66:67], v19 offset:50176
    v_mfma_f32_16x16x32_bf16 v[204:207], v[104:107], v[124:127], v[204:207]
    ds_read_b64_tr_b16 v[68:69], v20 offset:49152
    v_mfma_f32_16x16x32_bf16 v[208:211], v[108:111], v[116:119], v[208:211]
    ds_read_b64_tr_b16 v[70:71], v20 offset:50176
    v_mfma_f32_16x16x32_bf16 v[212:215], v[108:111], v[120:123], v[212:215]
    v_mfma_f32_16x16x32_bf16 v[216:219], v[108:111], v[124:127], v[216:219]
    v_mfma_f32_16x16x32_bf16 v[220:223], v[112:115], v[116:119], v[220:223]
    v_mfma_f32_16x16x32_bf16 v[224:227], v[112:115], v[120:123], v[224:227]
    v_mfma_f32_16x16x32_bf16 v[228:231], v[112:115], v[124:127], v[228:231]
    s_waitcnt lgkmcnt(14)
    v_mfma_f32_16x16x32_bf16 v[136:139], v[40:43], v[72:75], v[136:139]
    ds_read_b128 v[116:119], v12 offset:18432
    v_mfma_f32_16x16x32_bf16 v[140:143], v[40:43], v[76:79], v[140:143]
    ds_read_b128 v[120:123], v12 offset:20480
    v_mfma_f32_16x16x32_bf16 v[144:147], v[40:43], v[80:83], v[144:147]
    ds_read_b128 v[124:127], v12 offset:22528
    s_waitcnt lgkmcnt(15)
    v_mfma_f32_16x16x32_bf16 v[148:151], v[44:47], v[72:75], v[148:151]
    ds_read_b64_tr_b16 v[84:85], v13 offset:57344
    v_mfma_f32_16x16x32_bf16 v[152:155], v[44:47], v[76:79], v[152:155]
    ds_read_b64_tr_b16 v[86:87], v13 offset:58368
    v_mfma_f32_16x16x32_bf16 v[156:159], v[44:47], v[80:83], v[156:159]
    ds_read_b64_tr_b16 v[88:89], v14 offset:57344
    s_waitcnt lgkmcnt(15)
    v_mfma_f32_16x16x32_bf16 v[160:163], v[48:51], v[72:75], v[160:163]
    ds_read_b64_tr_b16 v[90:91], v14 offset:58368
    v_mfma_f32_16x16x32_bf16 v[164:167], v[48:51], v[76:79], v[164:167]
    ds_read_b64_tr_b16 v[92:93], v15 offset:57344
    v_mfma_f32_16x16x32_bf16 v[168:171], v[48:51], v[80:83], v[168:171]
    ds_read_b64_tr_b16 v[94:95], v15 offset:58368
    s_waitcnt lgkmcnt(15)
    v_mfma_f32_16x16x32_bf16 v[172:175], v[52:55], v[72:75], v[172:175]
    ds_read_b64_tr_b16 v[96:97], v16 offset:57344
    v_mfma_f32_16x16x32_bf16 v[176:179], v[52:55], v[76:79], v[176:179]
    ds_read_b64_tr_b16 v[98:99], v16 offset:58368
    v_mfma_f32_16x16x32_bf16 v[180:183], v[52:55], v[80:83], v[180:183]
    ds_read_b64_tr_b16 v[100:101], v17 offset:57344
    v_mfma_f32_16x16x32_bf16 v[184:187], v[56:59], v[72:75], v[184:187]
    ds_read_b64_tr_b16 v[102:103], v17 offset:58368
    v_mfma_f32_16x16x32_bf16 v[188:191], v[56:59], v[76:79], v[188:191]
    ds_read_b64_tr_b16 v[104:105], v18 offset:57344
    v_mfma_f32_16x16x32_bf16 v[192:195], v[56:59], v[80:83], v[192:195]
    ds_read_b64_tr_b16 v[106:107], v18 offset:58368
    s_waitcnt lgkmcnt(15)
    v_mfma_f32_16x16x32_bf16 v[196:199], v[60:63], v[72:75], v[196:199]
    ds_read_b64_tr_b16 v[108:109], v19 offset:57344
    v_mfma_f32_16x16x32_bf16 v[200:203], v[60:63], v[76:79], v[200:203]
    ds_read_b64_tr_b16 v[110:111], v19 offset:58368
    v_mfma_f32_16x16x32_bf16 v[204:207], v[60:63], v[80:83], v[204:207]
    ds_read_b64_tr_b16 v[112:113], v20 offset:57344
    v_mfma_f32_16x16x32_bf16 v[208:211], v[64:67], v[72:75], v[208:211]
    ds_read_b64_tr_b16 v[114:115], v20 offset:58368
    v_mfma_f32_16x16x32_bf16 v[212:215], v[64:67], v[76:79], v[212:215]
    v_mfma_f32_16x16x32_bf16 v[216:219], v[64:67], v[80:83], v[216:219]
    v_mfma_f32_16x16x32_bf16 v[220:223], v[68:71], v[72:75], v[220:223]
    v_mfma_f32_16x16x32_bf16 v[224:227], v[68:71], v[76:79], v[224:227]
    v_mfma_f32_16x16x32_bf16 v[228:231], v[68:71], v[80:83], v[228:231]
    s_waitcnt lgkmcnt(0)
    s_barrier
    v_mfma_f32_16x16x32_bf16 v[136:139], v[84:87], v[116:119], v[136:139]
    ds_read_b128 v[72:75], v11 offset:0
    v_mfma_f32_16x16x32_bf16 v[140:143], v[84:87], v[120:123], v[140:143]
    ds_read_b128 v[76:79], v11 offset:2048
    v_mfma_f32_16x16x32_bf16 v[144:147], v[84:87], v[124:127], v[144:147]
    ds_read_b128 v[80:83], v11 offset:4096
    v_mfma_f32_16x16x32_bf16 v[148:151], v[88:91], v[116:119], v[148:151]
    ds_read_b64_tr_b16 v[40:41], v13 offset:0
    v_mfma_f32_16x16x32_bf16 v[152:155], v[88:91], v[120:123], v[152:155]
    ds_read_b64_tr_b16 v[42:43], v13 offset:1024
    v_mfma_f32_16x16x32_bf16 v[156:159], v[88:91], v[124:127], v[156:159]
    ds_read_b64_tr_b16 v[44:45], v14 offset:0
    v_mfma_f32_16x16x32_bf16 v[160:163], v[92:95], v[116:119], v[160:163]
    ds_read_b64_tr_b16 v[46:47], v14 offset:1024
    v_mfma_f32_16x16x32_bf16 v[164:167], v[92:95], v[120:123], v[164:167]
    ds_read_b64_tr_b16 v[48:49], v15 offset:0
    v_mfma_f32_16x16x32_bf16 v[168:171], v[92:95], v[124:127], v[168:171]
    ds_read_b64_tr_b16 v[50:51], v15 offset:1024
    v_mfma_f32_16x16x32_bf16 v[172:175], v[96:99], v[116:119], v[172:175]
    ds_read_b64_tr_b16 v[52:53], v16 offset:0
    v_mfma_f32_16x16x32_bf16 v[176:179], v[96:99], v[120:123], v[176:179]
    ds_read_b64_tr_b16 v[54:55], v16 offset:1024
    v_mfma_f32_16x16x32_bf16 v[180:183], v[96:99], v[124:127], v[180:183]
    ds_read_b64_tr_b16 v[56:57], v17 offset:0
    v_mfma_f32_16x16x32_bf16 v[184:187], v[100:103], v[116:119], v[184:187]
    ds_read_b64_tr_b16 v[58:59], v17 offset:1024
    v_mfma_f32_16x16x32_bf16 v[188:191], v[100:103], v[120:123], v[188:191]
    ds_read_b64_tr_b16 v[60:61], v18 offset:0
    v_mfma_f32_16x16x32_bf16 v[192:195], v[100:103], v[124:127], v[192:195]
    ds_read_b64_tr_b16 v[62:63], v18 offset:1024
    v_mfma_f32_16x16x32_bf16 v[196:199], v[104:107], v[116:119], v[196:199]
    ds_read_b64_tr_b16 v[64:65], v19 offset:0
    v_mfma_f32_16x16x32_bf16 v[200:203], v[104:107], v[120:123], v[200:203]
    ds_read_b64_tr_b16 v[66:67], v19 offset:1024
    v_mfma_f32_16x16x32_bf16 v[204:207], v[104:107], v[124:127], v[204:207]
    ds_read_b64_tr_b16 v[68:69], v20 offset:0
    v_mfma_f32_16x16x32_bf16 v[208:211], v[108:111], v[116:119], v[208:211]
    ds_read_b64_tr_b16 v[70:71], v20 offset:1024
    v_mfma_f32_16x16x32_bf16 v[212:215], v[108:111], v[120:123], v[212:215]
    v_mfma_f32_16x16x32_bf16 v[216:219], v[108:111], v[124:127], v[216:219]
    v_mfma_f32_16x16x32_bf16 v[220:223], v[112:115], v[116:119], v[220:223]
    v_mfma_f32_16x16x32_bf16 v[224:227], v[112:115], v[120:123], v[224:227]
    v_mfma_f32_16x16x32_bf16 v[228:231], v[112:115], v[124:127], v[228:231]
    s_waitcnt lgkmcnt(14)
    v_mfma_f32_16x16x32_bf16 v[136:139], v[40:43], v[72:75], v[136:139]
    ds_read_b128 v[116:119], v12 offset:0
    v_mfma_f32_16x16x32_bf16 v[140:143], v[40:43], v[76:79], v[140:143]
    ds_read_b128 v[120:123], v12 offset:2048
    v_mfma_f32_16x16x32_bf16 v[144:147], v[40:43], v[80:83], v[144:147]
    ds_read_b128 v[124:127], v12 offset:4096
    s_waitcnt lgkmcnt(15)
    v_mfma_f32_16x16x32_bf16 v[148:151], v[44:47], v[72:75], v[148:151]
    ds_read_b64_tr_b16 v[84:85], v13 offset:8192
    v_mfma_f32_16x16x32_bf16 v[152:155], v[44:47], v[76:79], v[152:155]
    ds_read_b64_tr_b16 v[86:87], v13 offset:9216
    v_mfma_f32_16x16x32_bf16 v[156:159], v[44:47], v[80:83], v[156:159]
    ds_read_b64_tr_b16 v[88:89], v14 offset:8192
    s_waitcnt lgkmcnt(15)
    v_mfma_f32_16x16x32_bf16 v[160:163], v[48:51], v[72:75], v[160:163]
    ds_read_b64_tr_b16 v[90:91], v14 offset:9216
    v_mfma_f32_16x16x32_bf16 v[164:167], v[48:51], v[76:79], v[164:167]
    ds_read_b64_tr_b16 v[92:93], v15 offset:8192
    v_mfma_f32_16x16x32_bf16 v[168:171], v[48:51], v[80:83], v[168:171]
    ds_read_b64_tr_b16 v[94:95], v15 offset:9216
    s_waitcnt lgkmcnt(15)
    v_mfma_f32_16x16x32_bf16 v[172:175], v[52:55], v[72:75], v[172:175]
    ds_read_b64_tr_b16 v[96:97], v16 offset:8192
    v_mfma_f32_16x16x32_bf16 v[176:179], v[52:55], v[76:79], v[176:179]
    ds_read_b64_tr_b16 v[98:99], v16 offset:9216
    v_mfma_f32_16x16x32_bf16 v[180:183], v[52:55], v[80:83], v[180:183]
    ds_read_b64_tr_b16 v[100:101], v17 offset:8192
    v_mfma_f32_16x16x32_bf16 v[184:187], v[56:59], v[72:75], v[184:187]
    ds_read_b64_tr_b16 v[102:103], v17 offset:9216
    v_mfma_f32_16x16x32_bf16 v[188:191], v[56:59], v[76:79], v[188:191]
    ds_read_b64_tr_b16 v[104:105], v18 offset:8192
    v_mfma_f32_16x16x32_bf16 v[192:195], v[56:59], v[80:83], v[192:195]
    ds_read_b64_tr_b16 v[106:107], v18 offset:9216
    s_waitcnt lgkmcnt(15)
    v_mfma_f32_16x16x32_bf16 v[196:199], v[60:63], v[72:75], v[196:199]
    ds_read_b64_tr_b16 v[108:109], v19 offset:8192
    v_mfma_f32_16x16x32_bf16 v[200:203], v[60:63], v[76:79], v[200:203]
    ds_read_b64_tr_b16 v[110:111], v19 offset:9216
    v_mfma_f32_16x16x32_bf16 v[204:207], v[60:63], v[80:83], v[204:207]
    ds_read_b64_tr_b16 v[112:113], v20 offset:8192
    v_mfma_f32_16x16x32_bf16 v[208:211], v[64:67], v[72:75], v[208:211]
    ds_read_b64_tr_b16 v[114:115], v20 offset:9216
    v_mfma_f32_16x16x32_bf16 v[212:215], v[64:67], v[76:79], v[212:215]
    v_mfma_f32_16x16x32_bf16 v[216:219], v[64:67], v[80:83], v[216:219]
    v_mfma_f32_16x16x32_bf16 v[220:223], v[68:71], v[72:75], v[220:223]
    v_mfma_f32_16x16x32_bf16 v[224:227], v[68:71], v[76:79], v[224:227]
    v_mfma_f32_16x16x32_bf16 v[228:231], v[68:71], v[80:83], v[228:231]
    s_waitcnt lgkmcnt(0)
    s_barrier
    v_mfma_f32_16x16x32_bf16 v[136:139], v[84:87], v[116:119], v[136:139]
    ds_read_b128 v[72:75], v11 offset:6144
    v_mfma_f32_16x16x32_bf16 v[140:143], v[84:87], v[120:123], v[140:143]
    ds_read_b128 v[76:79], v11 offset:8192
    v_mfma_f32_16x16x32_bf16 v[144:147], v[84:87], v[124:127], v[144:147]
    ds_read_b128 v[80:83], v11 offset:10240
    v_mfma_f32_16x16x32_bf16 v[148:151], v[88:91], v[116:119], v[148:151]
    ds_read_b64_tr_b16 v[40:41], v13 offset:16384
    v_mfma_f32_16x16x32_bf16 v[152:155], v[88:91], v[120:123], v[152:155]
    ds_read_b64_tr_b16 v[42:43], v13 offset:17408
    v_mfma_f32_16x16x32_bf16 v[156:159], v[88:91], v[124:127], v[156:159]
    ds_read_b64_tr_b16 v[44:45], v14 offset:16384
    v_mfma_f32_16x16x32_bf16 v[160:163], v[92:95], v[116:119], v[160:163]
    ds_read_b64_tr_b16 v[46:47], v14 offset:17408
    v_mfma_f32_16x16x32_bf16 v[164:167], v[92:95], v[120:123], v[164:167]
    ds_read_b64_tr_b16 v[48:49], v15 offset:16384
    v_mfma_f32_16x16x32_bf16 v[168:171], v[92:95], v[124:127], v[168:171]
    ds_read_b64_tr_b16 v[50:51], v15 offset:17408
    v_mfma_f32_16x16x32_bf16 v[172:175], v[96:99], v[116:119], v[172:175]
    ds_read_b64_tr_b16 v[52:53], v16 offset:16384
    v_mfma_f32_16x16x32_bf16 v[176:179], v[96:99], v[120:123], v[176:179]
    ds_read_b64_tr_b16 v[54:55], v16 offset:17408
    v_mfma_f32_16x16x32_bf16 v[180:183], v[96:99], v[124:127], v[180:183]
    ds_read_b64_tr_b16 v[56:57], v17 offset:16384
    v_mfma_f32_16x16x32_bf16 v[184:187], v[100:103], v[116:119], v[184:187]
    ds_read_b64_tr_b16 v[58:59], v17 offset:17408
    v_mfma_f32_16x16x32_bf16 v[188:191], v[100:103], v[120:123], v[188:191]
    ds_read_b64_tr_b16 v[60:61], v18 offset:16384
    v_mfma_f32_16x16x32_bf16 v[192:195], v[100:103], v[124:127], v[192:195]
    ds_read_b64_tr_b16 v[62:63], v18 offset:17408
    v_mfma_f32_16x16x32_bf16 v[196:199], v[104:107], v[116:119], v[196:199]
    ds_read_b64_tr_b16 v[64:65], v19 offset:16384
    v_mfma_f32_16x16x32_bf16 v[200:203], v[104:107], v[120:123], v[200:203]
    ds_read_b64_tr_b16 v[66:67], v19 offset:17408
    v_mfma_f32_16x16x32_bf16 v[204:207], v[104:107], v[124:127], v[204:207]
    ds_read_b64_tr_b16 v[68:69], v20 offset:16384
    v_mfma_f32_16x16x32_bf16 v[208:211], v[108:111], v[116:119], v[208:211]
    ds_read_b64_tr_b16 v[70:71], v20 offset:17408
    v_mfma_f32_16x16x32_bf16 v[212:215], v[108:111], v[120:123], v[212:215]
    v_mfma_f32_16x16x32_bf16 v[216:219], v[108:111], v[124:127], v[216:219]
    v_mfma_f32_16x16x32_bf16 v[220:223], v[112:115], v[116:119], v[220:223]
    v_mfma_f32_16x16x32_bf16 v[224:227], v[112:115], v[120:123], v[224:227]
    v_mfma_f32_16x16x32_bf16 v[228:231], v[112:115], v[124:127], v[228:231]
    s_waitcnt lgkmcnt(14)
    v_mfma_f32_16x16x32_bf16 v[136:139], v[40:43], v[72:75], v[136:139]
    ds_read_b128 v[116:119], v12 offset:6144
    v_mfma_f32_16x16x32_bf16 v[140:143], v[40:43], v[76:79], v[140:143]
    ds_read_b128 v[120:123], v12 offset:8192
    v_mfma_f32_16x16x32_bf16 v[144:147], v[40:43], v[80:83], v[144:147]
    ds_read_b128 v[124:127], v12 offset:10240
    s_waitcnt lgkmcnt(15)
    v_mfma_f32_16x16x32_bf16 v[148:151], v[44:47], v[72:75], v[148:151]
    ds_read_b64_tr_b16 v[84:85], v13 offset:24576
    v_mfma_f32_16x16x32_bf16 v[152:155], v[44:47], v[76:79], v[152:155]
    ds_read_b64_tr_b16 v[86:87], v13 offset:25600
    v_mfma_f32_16x16x32_bf16 v[156:159], v[44:47], v[80:83], v[156:159]
    ds_read_b64_tr_b16 v[88:89], v14 offset:24576
    s_waitcnt lgkmcnt(15)
    v_mfma_f32_16x16x32_bf16 v[160:163], v[48:51], v[72:75], v[160:163]
    ds_read_b64_tr_b16 v[90:91], v14 offset:25600
    v_mfma_f32_16x16x32_bf16 v[164:167], v[48:51], v[76:79], v[164:167]
    ds_read_b64_tr_b16 v[92:93], v15 offset:24576
    v_mfma_f32_16x16x32_bf16 v[168:171], v[48:51], v[80:83], v[168:171]
    ds_read_b64_tr_b16 v[94:95], v15 offset:25600
    s_waitcnt lgkmcnt(15)
    v_mfma_f32_16x16x32_bf16 v[172:175], v[52:55], v[72:75], v[172:175]
    ds_read_b64_tr_b16 v[96:97], v16 offset:24576
    v_mfma_f32_16x16x32_bf16 v[176:179], v[52:55], v[76:79], v[176:179]
    ds_read_b64_tr_b16 v[98:99], v16 offset:25600
    v_mfma_f32_16x16x32_bf16 v[180:183], v[52:55], v[80:83], v[180:183]
    ds_read_b64_tr_b16 v[100:101], v17 offset:24576
    v_mfma_f32_16x16x32_bf16 v[184:187], v[56:59], v[72:75], v[184:187]
    ds_read_b64_tr_b16 v[102:103], v17 offset:25600
    v_mfma_f32_16x16x32_bf16 v[188:191], v[56:59], v[76:79], v[188:191]
    ds_read_b64_tr_b16 v[104:105], v18 offset:24576
    v_mfma_f32_16x16x32_bf16 v[192:195], v[56:59], v[80:83], v[192:195]
    ds_read_b64_tr_b16 v[106:107], v18 offset:25600
    s_waitcnt lgkmcnt(15)
    v_mfma_f32_16x16x32_bf16 v[196:199], v[60:63], v[72:75], v[196:199]
    ds_read_b64_tr_b16 v[108:109], v19 offset:24576
    v_mfma_f32_16x16x32_bf16 v[200:203], v[60:63], v[76:79], v[200:203]
    ds_read_b64_tr_b16 v[110:111], v19 offset:25600
    v_mfma_f32_16x16x32_bf16 v[204:207], v[60:63], v[80:83], v[204:207]
    ds_read_b64_tr_b16 v[112:113], v20 offset:24576
    v_mfma_f32_16x16x32_bf16 v[208:211], v[64:67], v[72:75], v[208:211]
    ds_read_b64_tr_b16 v[114:115], v20 offset:25600
    v_mfma_f32_16x16x32_bf16 v[212:215], v[64:67], v[76:79], v[212:215]
    v_mfma_f32_16x16x32_bf16 v[216:219], v[64:67], v[80:83], v[216:219]
    v_mfma_f32_16x16x32_bf16 v[220:223], v[68:71], v[72:75], v[220:223]
    v_mfma_f32_16x16x32_bf16 v[224:227], v[68:71], v[76:79], v[224:227]
    v_mfma_f32_16x16x32_bf16 v[228:231], v[68:71], v[80:83], v[228:231]
    s_waitcnt lgkmcnt(0)
    s_barrier
    v_mfma_f32_16x16x32_bf16 v[136:139], v[84:87], v[116:119], v[136:139]
    ds_read_b128 v[72:75], v11 offset:12288
    v_mfma_f32_16x16x32_bf16 v[140:143], v[84:87], v[120:123], v[140:143]
    ds_read_b128 v[76:79], v11 offset:14336
    v_mfma_f32_16x16x32_bf16 v[144:147], v[84:87], v[124:127], v[144:147]
    ds_read_b128 v[80:83], v11 offset:16384
    v_mfma_f32_16x16x32_bf16 v[148:151], v[88:91], v[116:119], v[148:151]
    ds_read_b64_tr_b16 v[40:41], v13 offset:32768
    v_mfma_f32_16x16x32_bf16 v[152:155], v[88:91], v[120:123], v[152:155]
    ds_read_b64_tr_b16 v[42:43], v13 offset:33792
    v_mfma_f32_16x16x32_bf16 v[156:159], v[88:91], v[124:127], v[156:159]
    ds_read_b64_tr_b16 v[44:45], v14 offset:32768
    v_mfma_f32_16x16x32_bf16 v[160:163], v[92:95], v[116:119], v[160:163]
    ds_read_b64_tr_b16 v[46:47], v14 offset:33792
    v_mfma_f32_16x16x32_bf16 v[164:167], v[92:95], v[120:123], v[164:167]
    ds_read_b64_tr_b16 v[48:49], v15 offset:32768
    v_mfma_f32_16x16x32_bf16 v[168:171], v[92:95], v[124:127], v[168:171]
    ds_read_b64_tr_b16 v[50:51], v15 offset:33792
    v_mfma_f32_16x16x32_bf16 v[172:175], v[96:99], v[116:119], v[172:175]
    ds_read_b64_tr_b16 v[52:53], v16 offset:32768
    v_mfma_f32_16x16x32_bf16 v[176:179], v[96:99], v[120:123], v[176:179]
    ds_read_b64_tr_b16 v[54:55], v16 offset:33792
    v_mfma_f32_16x16x32_bf16 v[180:183], v[96:99], v[124:127], v[180:183]
    ds_read_b64_tr_b16 v[56:57], v17 offset:32768
    v_mfma_f32_16x16x32_bf16 v[184:187], v[100:103], v[116:119], v[184:187]
    ds_read_b64_tr_b16 v[58:59], v17 offset:33792
    v_mfma_f32_16x16x32_bf16 v[188:191], v[100:103], v[120:123], v[188:191]
    ds_read_b64_tr_b16 v[60:61], v18 offset:32768
    v_mfma_f32_16x16x32_bf16 v[192:195], v[100:103], v[124:127], v[192:195]
    ds_read_b64_tr_b16 v[62:63], v18 offset:33792
    v_mfma_f32_16x16x32_bf16 v[196:199], v[104:107], v[116:119], v[196:199]
    ds_read_b64_tr_b16 v[64:65], v19 offset:32768
    v_mfma_f32_16x16x32_bf16 v[200:203], v[104:107], v[120:123], v[200:203]
    ds_read_b64_tr_b16 v[66:67], v19 offset:33792
    v_mfma_f32_16x16x32_bf16 v[204:207], v[104:107], v[124:127], v[204:207]
    ds_read_b64_tr_b16 v[68:69], v20 offset:32768
    v_mfma_f32_16x16x32_bf16 v[208:211], v[108:111], v[116:119], v[208:211]
    ds_read_b64_tr_b16 v[70:71], v20 offset:33792
    v_mfma_f32_16x16x32_bf16 v[212:215], v[108:111], v[120:123], v[212:215]
    v_mfma_f32_16x16x32_bf16 v[216:219], v[108:111], v[124:127], v[216:219]
    v_mfma_f32_16x16x32_bf16 v[220:223], v[112:115], v[116:119], v[220:223]
    v_mfma_f32_16x16x32_bf16 v[224:227], v[112:115], v[120:123], v[224:227]
    v_mfma_f32_16x16x32_bf16 v[228:231], v[112:115], v[124:127], v[228:231]
    s_waitcnt lgkmcnt(14)
    v_mfma_f32_16x16x32_bf16 v[136:139], v[40:43], v[72:75], v[136:139]
    ds_read_b128 v[116:119], v12 offset:12288
    v_mfma_f32_16x16x32_bf16 v[140:143], v[40:43], v[76:79], v[140:143]
    ds_read_b128 v[120:123], v12 offset:14336
    v_mfma_f32_16x16x32_bf16 v[144:147], v[40:43], v[80:83], v[144:147]
    ds_read_b128 v[124:127], v12 offset:16384
    s_waitcnt lgkmcnt(15)
    v_mfma_f32_16x16x32_bf16 v[148:151], v[44:47], v[72:75], v[148:151]
    ds_read_b64_tr_b16 v[84:85], v13 offset:40960
    v_mfma_f32_16x16x32_bf16 v[152:155], v[44:47], v[76:79], v[152:155]
    ds_read_b64_tr_b16 v[86:87], v13 offset:41984
    v_mfma_f32_16x16x32_bf16 v[156:159], v[44:47], v[80:83], v[156:159]
    ds_read_b64_tr_b16 v[88:89], v14 offset:40960
    s_waitcnt lgkmcnt(15)
    v_mfma_f32_16x16x32_bf16 v[160:163], v[48:51], v[72:75], v[160:163]
    ds_read_b64_tr_b16 v[90:91], v14 offset:41984
    v_mfma_f32_16x16x32_bf16 v[164:167], v[48:51], v[76:79], v[164:167]
    ds_read_b64_tr_b16 v[92:93], v15 offset:40960
    v_mfma_f32_16x16x32_bf16 v[168:171], v[48:51], v[80:83], v[168:171]
    ds_read_b64_tr_b16 v[94:95], v15 offset:41984
    s_waitcnt lgkmcnt(15)
    v_mfma_f32_16x16x32_bf16 v[172:175], v[52:55], v[72:75], v[172:175]
    ds_read_b64_tr_b16 v[96:97], v16 offset:40960
    v_mfma_f32_16x16x32_bf16 v[176:179], v[52:55], v[76:79], v[176:179]
    ds_read_b64_tr_b16 v[98:99], v16 offset:41984
    v_mfma_f32_16x16x32_bf16 v[180:183], v[52:55], v[80:83], v[180:183]
    ds_read_b64_tr_b16 v[100:101], v17 offset:40960
    v_mfma_f32_16x16x32_bf16 v[184:187], v[56:59], v[72:75], v[184:187]
    ds_read_b64_tr_b16 v[102:103], v17 offset:41984
    v_mfma_f32_16x16x32_bf16 v[188:191], v[56:59], v[76:79], v[188:191]
    ds_read_b64_tr_b16 v[104:105], v18 offset:40960
    v_mfma_f32_16x16x32_bf16 v[192:195], v[56:59], v[80:83], v[192:195]
    ds_read_b64_tr_b16 v[106:107], v18 offset:41984
    s_waitcnt lgkmcnt(15)
    v_mfma_f32_16x16x32_bf16 v[196:199], v[60:63], v[72:75], v[196:199]
    ds_read_b64_tr_b16 v[108:109], v19 offset:40960
    v_mfma_f32_16x16x32_bf16 v[200:203], v[60:63], v[76:79], v[200:203]
    ds_read_b64_tr_b16 v[110:111], v19 offset:41984
    v_mfma_f32_16x16x32_bf16 v[204:207], v[60:63], v[80:83], v[204:207]
    ds_read_b64_tr_b16 v[112:113], v20 offset:40960
    v_mfma_f32_16x16x32_bf16 v[208:211], v[64:67], v[72:75], v[208:211]
    ds_read_b64_tr_b16 v[114:115], v20 offset:41984
    v_mfma_f32_16x16x32_bf16 v[212:215], v[64:67], v[76:79], v[212:215]
    v_mfma_f32_16x16x32_bf16 v[216:219], v[64:67], v[80:83], v[216:219]
    v_mfma_f32_16x16x32_bf16 v[220:223], v[68:71], v[72:75], v[220:223]
    v_mfma_f32_16x16x32_bf16 v[224:227], v[68:71], v[76:79], v[224:227]
    v_mfma_f32_16x16x32_bf16 v[228:231], v[68:71], v[80:83], v[228:231]
    s_waitcnt lgkmcnt(0)
    s_barrier
    v_mfma_f32_16x16x32_bf16 v[136:139], v[84:87], v[116:119], v[136:139]
    ds_read_b128 v[72:75], v11 offset:18432
    v_mfma_f32_16x16x32_bf16 v[140:143], v[84:87], v[120:123], v[140:143]
    ds_read_b128 v[76:79], v11 offset:20480
    v_mfma_f32_16x16x32_bf16 v[144:147], v[84:87], v[124:127], v[144:147]
    ds_read_b128 v[80:83], v11 offset:22528
    v_mfma_f32_16x16x32_bf16 v[148:151], v[88:91], v[116:119], v[148:151]
    ds_read_b64_tr_b16 v[40:41], v13 offset:49152
    v_mfma_f32_16x16x32_bf16 v[152:155], v[88:91], v[120:123], v[152:155]
    ds_read_b64_tr_b16 v[42:43], v13 offset:50176
    v_mfma_f32_16x16x32_bf16 v[156:159], v[88:91], v[124:127], v[156:159]
    ds_read_b64_tr_b16 v[44:45], v14 offset:49152
    v_mfma_f32_16x16x32_bf16 v[160:163], v[92:95], v[116:119], v[160:163]
    ds_read_b64_tr_b16 v[46:47], v14 offset:50176
    v_mfma_f32_16x16x32_bf16 v[164:167], v[92:95], v[120:123], v[164:167]
    ds_read_b64_tr_b16 v[48:49], v15 offset:49152
    v_mfma_f32_16x16x32_bf16 v[168:171], v[92:95], v[124:127], v[168:171]
    ds_read_b64_tr_b16 v[50:51], v15 offset:50176
    v_mfma_f32_16x16x32_bf16 v[172:175], v[96:99], v[116:119], v[172:175]
    ds_read_b64_tr_b16 v[52:53], v16 offset:49152
    v_mfma_f32_16x16x32_bf16 v[176:179], v[96:99], v[120:123], v[176:179]
    ds_read_b64_tr_b16 v[54:55], v16 offset:50176
    v_mfma_f32_16x16x32_bf16 v[180:183], v[96:99], v[124:127], v[180:183]
    ds_read_b64_tr_b16 v[56:57], v17 offset:49152
    v_mfma_f32_16x16x32_bf16 v[184:187], v[100:103], v[116:119], v[184:187]
    ds_read_b64_tr_b16 v[58:59], v17 offset:50176
    v_mfma_f32_16x16x32_bf16 v[188:191], v[100:103], v[120:123], v[188:191]
    ds_read_b64_tr_b16 v[60:61], v18 offset:49152
    v_mfma_f32_16x16x32_bf16 v[192:195], v[100:103], v[124:127], v[192:195]
    ds_read_b64_tr_b16 v[62:63], v18 offset:50176
    v_mfma_f32_16x16x32_bf16 v[196:199], v[104:107], v[116:119], v[196:199]
    ds_read_b64_tr_b16 v[64:65], v19 offset:49152
    v_mfma_f32_16x16x32_bf16 v[200:203], v[104:107], v[120:123], v[200:203]
    ds_read_b64_tr_b16 v[66:67], v19 offset:50176
    v_mfma_f32_16x16x32_bf16 v[204:207], v[104:107], v[124:127], v[204:207]
    ds_read_b64_tr_b16 v[68:69], v20 offset:49152
    v_mfma_f32_16x16x32_bf16 v[208:211], v[108:111], v[116:119], v[208:211]
    ds_read_b64_tr_b16 v[70:71], v20 offset:50176
    v_mfma_f32_16x16x32_bf16 v[212:215], v[108:111], v[120:123], v[212:215]
    v_mfma_f32_16x16x32_bf16 v[216:219], v[108:111], v[124:127], v[216:219]
    v_mfma_f32_16x16x32_bf16 v[220:223], v[112:115], v[116:119], v[220:223]
    v_mfma_f32_16x16x32_bf16 v[224:227], v[112:115], v[120:123], v[224:227]
    v_mfma_f32_16x16x32_bf16 v[228:231], v[112:115], v[124:127], v[228:231]
    s_waitcnt lgkmcnt(14)
    v_mfma_f32_16x16x32_bf16 v[136:139], v[40:43], v[72:75], v[136:139]
    ds_read_b128 v[116:119], v12 offset:18432
    v_mfma_f32_16x16x32_bf16 v[140:143], v[40:43], v[76:79], v[140:143]
    ds_read_b128 v[120:123], v12 offset:20480
    v_mfma_f32_16x16x32_bf16 v[144:147], v[40:43], v[80:83], v[144:147]
    ds_read_b128 v[124:127], v12 offset:22528
    s_waitcnt lgkmcnt(15)
    v_mfma_f32_16x16x32_bf16 v[148:151], v[44:47], v[72:75], v[148:151]
    ds_read_b64_tr_b16 v[84:85], v13 offset:57344
    v_mfma_f32_16x16x32_bf16 v[152:155], v[44:47], v[76:79], v[152:155]
    ds_read_b64_tr_b16 v[86:87], v13 offset:58368
    v_mfma_f32_16x16x32_bf16 v[156:159], v[44:47], v[80:83], v[156:159]
    ds_read_b64_tr_b16 v[88:89], v14 offset:57344
    s_waitcnt lgkmcnt(15)
    v_mfma_f32_16x16x32_bf16 v[160:163], v[48:51], v[72:75], v[160:163]
    ds_read_b64_tr_b16 v[90:91], v14 offset:58368
    v_mfma_f32_16x16x32_bf16 v[164:167], v[48:51], v[76:79], v[164:167]
    ds_read_b64_tr_b16 v[92:93], v15 offset:57344
    v_mfma_f32_16x16x32_bf16 v[168:171], v[48:51], v[80:83], v[168:171]
    ds_read_b64_tr_b16 v[94:95], v15 offset:58368
    s_waitcnt lgkmcnt(15)
    v_mfma_f32_16x16x32_bf16 v[172:175], v[52:55], v[72:75], v[172:175]
    ds_read_b64_tr_b16 v[96:97], v16 offset:57344
    v_mfma_f32_16x16x32_bf16 v[176:179], v[52:55], v[76:79], v[176:179]
    ds_read_b64_tr_b16 v[98:99], v16 offset:58368
    v_mfma_f32_16x16x32_bf16 v[180:183], v[52:55], v[80:83], v[180:183]
    ds_read_b64_tr_b16 v[100:101], v17 offset:57344
    v_mfma_f32_16x16x32_bf16 v[184:187], v[56:59], v[72:75], v[184:187]
    ds_read_b64_tr_b16 v[102:103], v17 offset:58368
    v_mfma_f32_16x16x32_bf16 v[188:191], v[56:59], v[76:79], v[188:191]
    ds_read_b64_tr_b16 v[104:105], v18 offset:57344
    v_mfma_f32_16x16x32_bf16 v[192:195], v[56:59], v[80:83], v[192:195]
    ds_read_b64_tr_b16 v[106:107], v18 offset:58368
    s_waitcnt lgkmcnt(15)
    v_mfma_f32_16x16x32_bf16 v[196:199], v[60:63], v[72:75], v[196:199]
    ds_read_b64_tr_b16 v[108:109], v19 offset:57344
    v_mfma_f32_16x16x32_bf16 v[200:203], v[60:63], v[76:79], v[200:203]
    ds_read_b64_tr_b16 v[110:111], v19 offset:58368
    v_mfma_f32_16x16x32_bf16 v[204:207], v[60:63], v[80:83], v[204:207]
    ds_read_b64_tr_b16 v[112:113], v20 offset:57344
    v_mfma_f32_16x16x32_bf16 v[208:211], v[64:67], v[72:75], v[208:211]
    ds_read_b64_tr_b16 v[114:115], v20 offset:58368
    v_mfma_f32_16x16x32_bf16 v[212:215], v[64:67], v[76:79], v[212:215]
    v_mfma_f32_16x16x32_bf16 v[216:219], v[64:67], v[80:83], v[216:219]
    v_mfma_f32_16x16x32_bf16 v[220:223], v[68:71], v[72:75], v[220:223]
    v_mfma_f32_16x16x32_bf16 v[224:227], v[68:71], v[76:79], v[224:227]
    v_mfma_f32_16x16x32_bf16 v[228:231], v[68:71], v[80:83], v[228:231]
    s_waitcnt lgkmcnt(0)
    s_barrier
    v_mfma_f32_16x16x32_bf16 v[136:139], v[84:87], v[116:119], v[136:139]
    ds_read_b128 v[72:75], v11 offset:0
    v_mfma_f32_16x16x32_bf16 v[140:143], v[84:87], v[120:123], v[140:143]
    ds_read_b128 v[76:79], v11 offset:2048
    v_mfma_f32_16x16x32_bf16 v[144:147], v[84:87], v[124:127], v[144:147]
    ds_read_b128 v[80:83], v11 offset:4096
    v_mfma_f32_16x16x32_bf16 v[148:151], v[88:91], v[116:119], v[148:151]
    ds_read_b64_tr_b16 v[40:41], v13 offset:0
    v_mfma_f32_16x16x32_bf16 v[152:155], v[88:91], v[120:123], v[152:155]
    ds_read_b64_tr_b16 v[42:43], v13 offset:1024
    v_mfma_f32_16x16x32_bf16 v[156:159], v[88:91], v[124:127], v[156:159]
    ds_read_b64_tr_b16 v[44:45], v14 offset:0
    v_mfma_f32_16x16x32_bf16 v[160:163], v[92:95], v[116:119], v[160:163]
    ds_read_b64_tr_b16 v[46:47], v14 offset:1024
    v_mfma_f32_16x16x32_bf16 v[164:167], v[92:95], v[120:123], v[164:167]
    ds_read_b64_tr_b16 v[48:49], v15 offset:0
    v_mfma_f32_16x16x32_bf16 v[168:171], v[92:95], v[124:127], v[168:171]
    ds_read_b64_tr_b16 v[50:51], v15 offset:1024
    v_mfma_f32_16x16x32_bf16 v[172:175], v[96:99], v[116:119], v[172:175]
    ds_read_b64_tr_b16 v[52:53], v16 offset:0
    v_mfma_f32_16x16x32_bf16 v[176:179], v[96:99], v[120:123], v[176:179]
    ds_read_b64_tr_b16 v[54:55], v16 offset:1024
    v_mfma_f32_16x16x32_bf16 v[180:183], v[96:99], v[124:127], v[180:183]
    ds_read_b64_tr_b16 v[56:57], v17 offset:0
    v_mfma_f32_16x16x32_bf16 v[184:187], v[100:103], v[116:119], v[184:187]
    ds_read_b64_tr_b16 v[58:59], v17 offset:1024
    v_mfma_f32_16x16x32_bf16 v[188:191], v[100:103], v[120:123], v[188:191]
    ds_read_b64_tr_b16 v[60:61], v18 offset:0
    v_mfma_f32_16x16x32_bf16 v[192:195], v[100:103], v[124:127], v[192:195]
    ds_read_b64_tr_b16 v[62:63], v18 offset:1024
    v_mfma_f32_16x16x32_bf16 v[196:199], v[104:107], v[116:119], v[196:199]
    ds_read_b64_tr_b16 v[64:65], v19 offset:0
    v_mfma_f32_16x16x32_bf16 v[200:203], v[104:107], v[120:123], v[200:203]
    ds_read_b64_tr_b16 v[66:67], v19 offset:1024
    v_mfma_f32_16x16x32_bf16 v[204:207], v[104:107], v[124:127], v[204:207]
    ds_read_b64_tr_b16 v[68:69], v20 offset:0
    v_mfma_f32_16x16x32_bf16 v[208:211], v[108:111], v[116:119], v[208:211]
    ds_read_b64_tr_b16 v[70:71], v20 offset:1024
    v_mfma_f32_16x16x32_bf16 v[212:215], v[108:111], v[120:123], v[212:215]
    v_mfma_f32_16x16x32_bf16 v[216:219], v[108:111], v[124:127], v[216:219]
    v_mfma_f32_16x16x32_bf16 v[220:223], v[112:115], v[116:119], v[220:223]
    v_mfma_f32_16x16x32_bf16 v[224:227], v[112:115], v[120:123], v[224:227]
    v_mfma_f32_16x16x32_bf16 v[228:231], v[112:115], v[124:127], v[228:231]
    s_waitcnt lgkmcnt(14)
    v_mfma_f32_16x16x32_bf16 v[136:139], v[40:43], v[72:75], v[136:139]
    ds_read_b128 v[116:119], v12 offset:0
    v_mfma_f32_16x16x32_bf16 v[140:143], v[40:43], v[76:79], v[140:143]
    ds_read_b128 v[120:123], v12 offset:2048
    v_mfma_f32_16x16x32_bf16 v[144:147], v[40:43], v[80:83], v[144:147]
    ds_read_b128 v[124:127], v12 offset:4096
    s_waitcnt lgkmcnt(15)
    v_mfma_f32_16x16x32_bf16 v[148:151], v[44:47], v[72:75], v[148:151]
    ds_read_b64_tr_b16 v[84:85], v13 offset:8192
    v_mfma_f32_16x16x32_bf16 v[152:155], v[44:47], v[76:79], v[152:155]
    ds_read_b64_tr_b16 v[86:87], v13 offset:9216
    v_mfma_f32_16x16x32_bf16 v[156:159], v[44:47], v[80:83], v[156:159]
    ds_read_b64_tr_b16 v[88:89], v14 offset:8192
    s_waitcnt lgkmcnt(15)
    v_mfma_f32_16x16x32_bf16 v[160:163], v[48:51], v[72:75], v[160:163]
    ds_read_b64_tr_b16 v[90:91], v14 offset:9216
    v_mfma_f32_16x16x32_bf16 v[164:167], v[48:51], v[76:79], v[164:167]
    ds_read_b64_tr_b16 v[92:93], v15 offset:8192
    v_mfma_f32_16x16x32_bf16 v[168:171], v[48:51], v[80:83], v[168:171]
    ds_read_b64_tr_b16 v[94:95], v15 offset:9216
    s_waitcnt lgkmcnt(15)
    v_mfma_f32_16x16x32_bf16 v[172:175], v[52:55], v[72:75], v[172:175]
    ds_read_b64_tr_b16 v[96:97], v16 offset:8192
    v_mfma_f32_16x16x32_bf16 v[176:179], v[52:55], v[76:79], v[176:179]
    ds_read_b64_tr_b16 v[98:99], v16 offset:9216
    v_mfma_f32_16x16x32_bf16 v[180:183], v[52:55], v[80:83], v[180:183]
    ds_read_b64_tr_b16 v[100:101], v17 offset:8192
    v_mfma_f32_16x16x32_bf16 v[184:187], v[56:59], v[72:75], v[184:187]
    ds_read_b64_tr_b16 v[102:103], v17 offset:9216
    v_mfma_f32_16x16x32_bf16 v[188:191], v[56:59], v[76:79], v[188:191]
    ds_read_b64_tr_b16 v[104:105], v18 offset:8192
    v_mfma_f32_16x16x32_bf16 v[192:195], v[56:59], v[80:83], v[192:195]
    ds_read_b64_tr_b16 v[106:107], v18 offset:9216
    s_waitcnt lgkmcnt(15)
    v_mfma_f32_16x16x32_bf16 v[196:199], v[60:63], v[72:75], v[196:199]
    ds_read_b64_tr_b16 v[108:109], v19 offset:8192
    v_mfma_f32_16x16x32_bf16 v[200:203], v[60:63], v[76:79], v[200:203]
    ds_read_b64_tr_b16 v[110:111], v19 offset:9216
    v_mfma_f32_16x16x32_bf16 v[204:207], v[60:63], v[80:83], v[204:207]
    ds_read_b64_tr_b16 v[112:113], v20 offset:8192
    v_mfma_f32_16x16x32_bf16 v[208:211], v[64:67], v[72:75], v[208:211]
    ds_read_b64_tr_b16 v[114:115], v20 offset:9216
    v_mfma_f32_16x16x32_bf16 v[212:215], v[64:67], v[76:79], v[212:215]
    v_mfma_f32_16x16x32_bf16 v[216:219], v[64:67], v[80:83], v[216:219]
    v_mfma_f32_16x16x32_bf16 v[220:223], v[68:71], v[72:75], v[220:223]
    v_mfma_f32_16x16x32_bf16 v[224:227], v[68:71], v[76:79], v[224:227]
    v_mfma_f32_16x16x32_bf16 v[228:231], v[68:71], v[80:83], v[228:231]
    s_waitcnt lgkmcnt(0)
    s_barrier
    v_mfma_f32_16x16x32_bf16 v[136:139], v[84:87], v[116:119], v[136:139]
    ds_read_b128 v[72:75], v11 offset:6144
    v_mfma_f32_16x16x32_bf16 v[140:143], v[84:87], v[120:123], v[140:143]
    ds_read_b128 v[76:79], v11 offset:8192
    v_mfma_f32_16x16x32_bf16 v[144:147], v[84:87], v[124:127], v[144:147]
    ds_read_b128 v[80:83], v11 offset:10240
    v_mfma_f32_16x16x32_bf16 v[148:151], v[88:91], v[116:119], v[148:151]
    ds_read_b64_tr_b16 v[40:41], v13 offset:16384
    v_mfma_f32_16x16x32_bf16 v[152:155], v[88:91], v[120:123], v[152:155]
    ds_read_b64_tr_b16 v[42:43], v13 offset:17408
    v_mfma_f32_16x16x32_bf16 v[156:159], v[88:91], v[124:127], v[156:159]
    ds_read_b64_tr_b16 v[44:45], v14 offset:16384
    v_mfma_f32_16x16x32_bf16 v[160:163], v[92:95], v[116:119], v[160:163]
    ds_read_b64_tr_b16 v[46:47], v14 offset:17408
    v_mfma_f32_16x16x32_bf16 v[164:167], v[92:95], v[120:123], v[164:167]
    ds_read_b64_tr_b16 v[48:49], v15 offset:16384
    v_mfma_f32_16x16x32_bf16 v[168:171], v[92:95], v[124:127], v[168:171]
    ds_read_b64_tr_b16 v[50:51], v15 offset:17408
    v_mfma_f32_16x16x32_bf16 v[172:175], v[96:99], v[116:119], v[172:175]
    ds_read_b64_tr_b16 v[52:53], v16 offset:16384
    v_mfma_f32_16x16x32_bf16 v[176:179], v[96:99], v[120:123], v[176:179]
    ds_read_b64_tr_b16 v[54:55], v16 offset:17408
    v_mfma_f32_16x16x32_bf16 v[180:183], v[96:99], v[124:127], v[180:183]
    ds_read_b64_tr_b16 v[56:57], v17 offset:16384
    v_mfma_f32_16x16x32_bf16 v[184:187], v[100:103], v[116:119], v[184:187]
    ds_read_b64_tr_b16 v[58:59], v17 offset:17408
    v_mfma_f32_16x16x32_bf16 v[188:191], v[100:103], v[120:123], v[188:191]
    ds_read_b64_tr_b16 v[60:61], v18 offset:16384
    v_mfma_f32_16x16x32_bf16 v[192:195], v[100:103], v[124:127], v[192:195]
    ds_read_b64_tr_b16 v[62:63], v18 offset:17408
    v_mfma_f32_16x16x32_bf16 v[196:199], v[104:107], v[116:119], v[196:199]
    ds_read_b64_tr_b16 v[64:65], v19 offset:16384
    v_mfma_f32_16x16x32_bf16 v[200:203], v[104:107], v[120:123], v[200:203]
    ds_read_b64_tr_b16 v[66:67], v19 offset:17408
    v_mfma_f32_16x16x32_bf16 v[204:207], v[104:107], v[124:127], v[204:207]
    ds_read_b64_tr_b16 v[68:69], v20 offset:16384
    v_mfma_f32_16x16x32_bf16 v[208:211], v[108:111], v[116:119], v[208:211]
    ds_read_b64_tr_b16 v[70:71], v20 offset:17408
    v_mfma_f32_16x16x32_bf16 v[212:215], v[108:111], v[120:123], v[212:215]
    v_mfma_f32_16x16x32_bf16 v[216:219], v[108:111], v[124:127], v[216:219]
    v_mfma_f32_16x16x32_bf16 v[220:223], v[112:115], v[116:119], v[220:223]
    v_mfma_f32_16x16x32_bf16 v[224:227], v[112:115], v[120:123], v[224:227]
    v_mfma_f32_16x16x32_bf16 v[228:231], v[112:115], v[124:127], v[228:231]
    s_waitcnt lgkmcnt(14)
    v_mfma_f32_16x16x32_bf16 v[136:139], v[40:43], v[72:75], v[136:139]
    ds_read_b128 v[116:119], v12 offset:6144
    v_mfma_f32_16x16x32_bf16 v[140:143], v[40:43], v[76:79], v[140:143]
    ds_read_b128 v[120:123], v12 offset:8192
    v_mfma_f32_16x16x32_bf16 v[144:147], v[40:43], v[80:83], v[144:147]
    ds_read_b128 v[124:127], v12 offset:10240
    s_waitcnt lgkmcnt(15)
    v_mfma_f32_16x16x32_bf16 v[148:151], v[44:47], v[72:75], v[148:151]
    ds_read_b64_tr_b16 v[84:85], v13 offset:24576
    v_mfma_f32_16x16x32_bf16 v[152:155], v[44:47], v[76:79], v[152:155]
    ds_read_b64_tr_b16 v[86:87], v13 offset:25600
    v_mfma_f32_16x16x32_bf16 v[156:159], v[44:47], v[80:83], v[156:159]
    ds_read_b64_tr_b16 v[88:89], v14 offset:24576
    s_waitcnt lgkmcnt(15)
    v_mfma_f32_16x16x32_bf16 v[160:163], v[48:51], v[72:75], v[160:163]
    ds_read_b64_tr_b16 v[90:91], v14 offset:25600
    v_mfma_f32_16x16x32_bf16 v[164:167], v[48:51], v[76:79], v[164:167]
    ds_read_b64_tr_b16 v[92:93], v15 offset:24576
    v_mfma_f32_16x16x32_bf16 v[168:171], v[48:51], v[80:83], v[168:171]
    ds_read_b64_tr_b16 v[94:95], v15 offset:25600
    s_waitcnt lgkmcnt(15)
    v_mfma_f32_16x16x32_bf16 v[172:175], v[52:55], v[72:75], v[172:175]
    ds_read_b64_tr_b16 v[96:97], v16 offset:24576
    v_mfma_f32_16x16x32_bf16 v[176:179], v[52:55], v[76:79], v[176:179]
    ds_read_b64_tr_b16 v[98:99], v16 offset:25600
    v_mfma_f32_16x16x32_bf16 v[180:183], v[52:55], v[80:83], v[180:183]
    ds_read_b64_tr_b16 v[100:101], v17 offset:24576
    v_mfma_f32_16x16x32_bf16 v[184:187], v[56:59], v[72:75], v[184:187]
    ds_read_b64_tr_b16 v[102:103], v17 offset:25600
    v_mfma_f32_16x16x32_bf16 v[188:191], v[56:59], v[76:79], v[188:191]
    ds_read_b64_tr_b16 v[104:105], v18 offset:24576
    v_mfma_f32_16x16x32_bf16 v[192:195], v[56:59], v[80:83], v[192:195]
    ds_read_b64_tr_b16 v[106:107], v18 offset:25600
    s_waitcnt lgkmcnt(15)
    v_mfma_f32_16x16x32_bf16 v[196:199], v[60:63], v[72:75], v[196:199]
    ds_read_b64_tr_b16 v[108:109], v19 offset:24576
    v_mfma_f32_16x16x32_bf16 v[200:203], v[60:63], v[76:79], v[200:203]
    ds_read_b64_tr_b16 v[110:111], v19 offset:25600
    v_mfma_f32_16x16x32_bf16 v[204:207], v[60:63], v[80:83], v[204:207]
    ds_read_b64_tr_b16 v[112:113], v20 offset:24576
    v_mfma_f32_16x16x32_bf16 v[208:211], v[64:67], v[72:75], v[208:211]
    ds_read_b64_tr_b16 v[114:115], v20 offset:25600
    v_mfma_f32_16x16x32_bf16 v[212:215], v[64:67], v[76:79], v[212:215]
    v_mfma_f32_16x16x32_bf16 v[216:219], v[64:67], v[80:83], v[216:219]
    v_mfma_f32_16x16x32_bf16 v[220:223], v[68:71], v[72:75], v[220:223]
    v_mfma_f32_16x16x32_bf16 v[224:227], v[68:71], v[76:79], v[224:227]
    v_mfma_f32_16x16x32_bf16 v[228:231], v[68:71], v[80:83], v[228:231]
    s_waitcnt lgkmcnt(0)
    s_barrier
    v_mfma_f32_16x16x32_bf16 v[136:139], v[84:87], v[116:119], v[136:139]
    v_mfma_f32_16x16x32_bf16 v[148:151], v[88:91], v[116:119], v[148:151]
    v_mfma_f32_16x16x32_bf16 v[160:163], v[92:95], v[116:119], v[160:163]
    v_mfma_f32_16x16x32_bf16 v[172:175], v[96:99], v[116:119], v[172:175]
    v_mfma_f32_16x16x32_bf16 v[184:187], v[100:103], v[116:119], v[184:187]
    v_mfma_f32_16x16x32_bf16 v[196:199], v[104:107], v[116:119], v[196:199]
    v_mfma_f32_16x16x32_bf16 v[208:211], v[108:111], v[116:119], v[208:211]
    v_mfma_f32_16x16x32_bf16 v[220:223], v[112:115], v[116:119], v[220:223]
    v_mfma_f32_16x16x32_bf16 v[140:143], v[84:87], v[120:123], v[140:143]
    v_mfma_f32_16x16x32_bf16 v[152:155], v[88:91], v[120:123], v[152:155]
    v_mfma_f32_16x16x32_bf16 v[164:167], v[92:95], v[120:123], v[164:167]
    v_mfma_f32_16x16x32_bf16 v[176:179], v[96:99], v[120:123], v[176:179]
    v_mfma_f32_16x16x32_bf16 v[188:191], v[100:103], v[120:123], v[188:191]
    v_mfma_f32_16x16x32_bf16 v[200:203], v[104:107], v[120:123], v[200:203]
    v_mfma_f32_16x16x32_bf16 v[212:215], v[108:111], v[120:123], v[212:215]
    v_mfma_f32_16x16x32_bf16 v[224:227], v[112:115], v[120:123], v[224:227]
    v_mfma_f32_16x16x32_bf16 v[144:147], v[84:87], v[124:127], v[144:147]
    v_mfma_f32_16x16x32_bf16 v[156:159], v[88:91], v[124:127], v[156:159]
    v_mfma_f32_16x16x32_bf16 v[168:171], v[92:95], v[124:127], v[168:171]
    v_mfma_f32_16x16x32_bf16 v[180:183], v[96:99], v[124:127], v[180:183]
    v_mfma_f32_16x16x32_bf16 v[192:195], v[100:103], v[124:127], v[192:195]
    v_mfma_f32_16x16x32_bf16 v[204:207], v[104:107], v[124:127], v[204:207]
    v_mfma_f32_16x16x32_bf16 v[216:219], v[108:111], v[124:127], v[216:219]
    v_mfma_f32_16x16x32_bf16 v[228:231], v[112:115], v[124:127], v[228:231]
    v_cvt_pk_bf16_f32 v84, v136, v137
    v_cvt_pk_bf16_f32 v85, v138, v139
    v_cvt_pk_bf16_f32 v86, v148, v149
    v_cvt_pk_bf16_f32 v87, v150, v151
    v_cvt_pk_bf16_f32 v96, v160, v161
    v_cvt_pk_bf16_f32 v97, v162, v163
    v_cvt_pk_bf16_f32 v98, v172, v173
    v_cvt_pk_bf16_f32 v99, v174, v175
    v_cvt_pk_bf16_f32 v108, v184, v185
    v_cvt_pk_bf16_f32 v109, v186, v187
    v_cvt_pk_bf16_f32 v110, v196, v197
    v_cvt_pk_bf16_f32 v111, v198, v199
    v_cvt_pk_bf16_f32 v120, v208, v209
    v_cvt_pk_bf16_f32 v121, v210, v211
    v_cvt_pk_bf16_f32 v122, v220, v221
    v_cvt_pk_bf16_f32 v123, v222, v223
    s_barrier
    ds_read_b64 v[40:41], v29 offset:12288
    v_cvt_pk_bf16_f32 v88, v140, v141
    v_cvt_pk_bf16_f32 v89, v142, v143
    ds_read_b64 v[42:43], v30 offset:12288
    v_cvt_pk_bf16_f32 v90, v152, v153
    v_cvt_pk_bf16_f32 v91, v154, v155
    ds_read_b64 v[44:45], v31 offset:12288
    v_cvt_pk_bf16_f32 v100, v164, v165
    v_cvt_pk_bf16_f32 v101, v166, v167
    ds_read_b64 v[46:47], v32 offset:12288
    v_cvt_pk_bf16_f32 v102, v176, v177
    v_cvt_pk_bf16_f32 v103, v178, v179
    ds_read_b64 v[48:49], v33 offset:12288
    v_cvt_pk_bf16_f32 v112, v188, v189
    v_cvt_pk_bf16_f32 v113, v190, v191
    ds_read_b64 v[50:51], v34 offset:12288
    v_cvt_pk_bf16_f32 v114, v200, v201
    v_cvt_pk_bf16_f32 v115, v202, v203
    ds_read_b64 v[52:53], v35 offset:12288
    v_cvt_pk_bf16_f32 v124, v212, v213
    v_cvt_pk_bf16_f32 v125, v214, v215
    ds_read_b64 v[54:55], v36 offset:12288
    v_cvt_pk_bf16_f32 v126, v224, v225
    v_cvt_pk_bf16_f32 v127, v226, v227
    ds_read_b64 v[56:57], v29 offset:16384
    v_cvt_pk_bf16_f32 v92, v144, v145
    v_cvt_pk_bf16_f32 v93, v146, v147
    ds_read_b64 v[58:59], v30 offset:16384
    v_cvt_pk_bf16_f32 v94, v156, v157
    v_cvt_pk_bf16_f32 v95, v158, v159
    ds_read_b64 v[60:61], v31 offset:16384
    v_cvt_pk_bf16_f32 v104, v168, v169
    v_cvt_pk_bf16_f32 v105, v170, v171
    ds_read_b64 v[62:63], v32 offset:16384
    v_cvt_pk_bf16_f32 v106, v180, v181
    v_cvt_pk_bf16_f32 v107, v182, v183
    ds_read_b64 v[64:65], v33 offset:16384
    v_cvt_pk_bf16_f32 v116, v192, v193
    v_cvt_pk_bf16_f32 v117, v194, v195
    ds_read_b64 v[66:67], v34 offset:16384
    v_cvt_pk_bf16_f32 v118, v204, v205
    v_cvt_pk_bf16_f32 v119, v206, v207
    ds_read_b64 v[68:69], v35 offset:16384
    v_cvt_pk_bf16_f32 v132, v216, v217
    v_cvt_pk_bf16_f32 v133, v218, v219
    ds_read_b64 v[70:71], v36 offset:16384
    v_cvt_pk_bf16_f32 v134, v228, v229
    v_cvt_pk_bf16_f32 v135, v230, v231
    ds_read_b64 v[72:73], v29 offset:20480
    ds_read_b64 v[74:75], v30 offset:20480
    ds_read_b64 v[76:77], v31 offset:20480
    ds_read_b64 v[78:79], v32 offset:20480
    ds_read_b64 v[80:81], v33 offset:20480
    ds_read_b64 v[82:83], v34 offset:20480
    ds_read_b64 v[128:129], v35 offset:20480
    ds_read_b64 v[130:131], v36 offset:20480
    s_waitcnt lgkmcnt(15)
    v_mfma_f32_16x16x32_bf16 v[136:139], v[40:43], v[84:87], 0
    s_waitcnt lgkmcnt(14)
    v_mfma_f32_16x16x32_bf16 v[148:151], v[56:59], v[84:87], 0
    s_waitcnt lgkmcnt(6)
    v_mfma_f32_16x16x32_bf16 v[160:163], v[72:75], v[84:87], 0
    v_mfma_f32_16x16x32_bf16 v[136:139], v[44:47], v[96:99], v[136:139]
    v_mfma_f32_16x16x32_bf16 v[148:151], v[60:63], v[96:99], v[148:151]
    s_waitcnt lgkmcnt(4)
    v_mfma_f32_16x16x32_bf16 v[160:163], v[76:79], v[96:99], v[160:163]
    v_mfma_f32_16x16x32_bf16 v[136:139], v[48:51], v[108:111], v[136:139]
    v_mfma_f32_16x16x32_bf16 v[148:151], v[64:67], v[108:111], v[148:151]
    s_waitcnt lgkmcnt(2)
    v_mfma_f32_16x16x32_bf16 v[160:163], v[80:83], v[108:111], v[160:163]
    v_mfma_f32_16x16x32_bf16 v[136:139], v[52:55], v[120:123], v[136:139]
    v_mfma_f32_16x16x32_bf16 v[148:151], v[68:71], v[120:123], v[148:151]
    s_waitcnt lgkmcnt(0)
    v_mfma_f32_16x16x32_bf16 v[160:163], v[128:131], v[120:123], v[160:163]
    v_mfma_f32_16x16x32_bf16 v[140:143], v[40:43], v[88:91], 0
    v_mfma_f32_16x16x32_bf16 v[152:155], v[56:59], v[88:91], 0
    v_mfma_f32_16x16x32_bf16 v[164:167], v[72:75], v[88:91], 0
    s_nop 1
    v_max3_f32 v37, v136, v137, v138
    v_max3_f32 v38, v139, v148, v149
    v_max3_f32 v37, v37, v150, v151
    v_mfma_f32_16x16x32_bf16 v[140:143], v[44:47], v[100:103], v[140:143]
    v_max3_f32 v38, v38, v160, v161
    v_max3_f32 v37, v37, v162, v163
    v_max_f32 v37, v37, v38
    v_mfma_f32_16x16x32_bf16 v[152:155], v[60:63], v[100:103], v[152:155]
    v_mov_b32 v38, v37
    s_nop 1
    v_permlane16_swap_b32 v37, v38
    v_max_f32 v37, v37, v38
    v_mfma_f32_16x16x32_bf16 v[164:167], v[76:79], v[100:103], v[164:167]
    v_mov_b32 v38, v37
    s_nop 1
    v_permlane32_swap_b32 v37, v38
    v_max_f32 v37, v37, v38
    v_mfma_f32_16x16x32_bf16 v[140:143], v[48:51], v[112:115], v[140:143]
    v_mul_f32 v37, s98, v37
    v_fma_f32 v136, v136, s98, -v37
    v_fma_f32 v137, v137, s98, -v37
    v_mfma_f32_16x16x32_bf16 v[152:155], v[64:67], v[112:115], v[152:155]
    v_fma_f32 v138, v138, s98, -v37
    v_fma_f32 v139, v139, s98, -v37
    v_fma_f32 v148, v148, s98, -v37
    v_mfma_f32_16x16x32_bf16 v[164:167], v[80:83], v[112:115], v[164:167]
    v_fma_f32 v149, v149, s98, -v37
    v_fma_f32 v150, v150, s98, -v37
    v_fma_f32 v151, v151, s98, -v37
    v_mfma_f32_16x16x32_bf16 v[140:143], v[52:55], v[124:127], v[140:143]
    v_fma_f32 v160, v160, s98, -v37
    v_fma_f32 v161, v161, s98, -v37
    v_fma_f32 v162, v162, s98, -v37
    v_mfma_f32_16x16x32_bf16 v[152:155], v[68:71], v[124:127], v[152:155]
    v_fma_f32 v163, v163, s98, -v37
    v_exp_f32 v136, v136
    v_exp_f32 v137, v137
    v_mfma_f32_16x16x32_bf16 v[164:167], v[128:131], v[124:127], v[164:167]
    v_exp_f32 v138, v138
    v_exp_f32 v139, v139
    v_exp_f32 v148, v148
    v_mfma_f32_16x16x32_bf16 v[144:147], v[40:43], v[92:95], 0
    v_exp_f32 v149, v149
    v_exp_f32 v150, v150
    v_exp_f32 v151, v151
    v_mfma_f32_16x16x32_bf16 v[156:159], v[56:59], v[92:95], 0
    v_exp_f32 v160, v160
    v_exp_f32 v161, v161
    v_exp_f32 v162, v162
    v_mfma_f32_16x16x32_bf16 v[168:171], v[72:75], v[92:95], 0
    v_exp_f32 v163, v163
    v_add_f32 v39, v136, v137
    v_add_f32 v38, v138, v139
    v_mfma_f32_16x16x32_bf16 v[144:147], v[44:47], v[104:107], v[144:147]
    v_add_f32 v39, v39, v148
    v_add_f32 v38, v38, v149
    v_add_f32 v39, v39, v150
    v_mfma_f32_16x16x32_bf16 v[156:159], v[60:63], v[104:107], v[156:159]
    v_add_f32 v38, v38, v151
    v_add_f32 v39, v39, v160
    v_add_f32 v38, v38, v161
    v_mfma_f32_16x16x32_bf16 v[168:171], v[76:79], v[104:107], v[168:171]
    v_add_f32 v39, v39, v162
    v_add_f32 v38, v38, v163
    v_add_f32 v39, v39, v38
    v_mfma_f32_16x16x32_bf16 v[144:147], v[48:51], v[116:119], v[144:147]
    v_mov_b32 v38, v39
    s_nop 1
    v_permlane16_swap_b32 v39, v38
    v_add_f32 v39, v39, v38
    v_mfma_f32_16x16x32_bf16 v[156:159], v[64:67], v[116:119], v[156:159]
    v_mov_b32 v38, v39
    s_nop 1
    v_permlane32_swap_b32 v39, v38
    v_add_f32 v39, v39, v38
    v_mfma_f32_16x16x32_bf16 v[168:171], v[80:83], v[116:119], v[168:171]
    v_rcp_f32 v39, v39
    s_nop 0
    v_mul_f32 v136, v136, v39
    v_mul_f32 v137, v137, v39
    v_mfma_f32_16x16x32_bf16 v[144:147], v[52:55], v[132:135], v[144:147]
    v_mul_f32 v138, v138, v39
    v_mul_f32 v139, v139, v39
    v_mul_f32 v148, v148, v39
    v_mfma_f32_16x16x32_bf16 v[156:159], v[68:71], v[132:135], v[156:159]
    v_mul_f32 v149, v149, v39
    v_mul_f32 v150, v150, v39
    v_mul_f32 v151, v151, v39
    v_mfma_f32_16x16x32_bf16 v[168:171], v[128:131], v[132:135], v[168:171]
    v_mul_f32 v160, v160, v39
    v_mul_f32 v161, v161, v39
    v_mul_f32 v162, v162, v39
    v_mul_f32 v163, v163, v39
    v_cvt_pk_bf16_f32 v232, v136, v137
    v_cvt_pk_bf16_f32 v233, v138, v139
    s_waitcnt vmcnt(1)
    v_cvt_pk_bf16_f32 v234, v148, v149
    s_waitcnt vmcnt(0)
    v_cvt_pk_bf16_f32 v235, v150, v151
    v_cvt_pk_bf16_f32 v236, v160, v161
    v_cvt_pk_bf16_f32 v237, v162, v163
    s_barrier
    ds_read_b64_tr_b16 v[176:177], v21 offset:0
    v_max3_f32 v37, v140, v141, v142
    ds_read_b64_tr_b16 v[178:179], v21 offset:4096
    v_max3_f32 v38, v143, v152, v153
    ds_read_b64_tr_b16 v[180:181], v21 offset:8192
    v_max3_f32 v37, v37, v154, v155
    ds_read_b64_tr_b16 v[182:183], v22 offset:0
    v_max3_f32 v38, v38, v164, v165
    ds_read_b64_tr_b16 v[184:185], v22 offset:4096
    v_max3_f32 v37, v37, v166, v167
    ds_read_b64_tr_b16 v[186:187], v22 offset:8192
    v_max_f32 v37, v37, v38
    ds_read_b64_tr_b16 v[188:189], v23 offset:0
    v_mov_b32 v38, v37
    ds_read_b64_tr_b16 v[190:191], v23 offset:4096
    s_nop 0
    v_permlane16_swap_b32 v37, v38
    ds_read_b64_tr_b16 v[192:193], v23 offset:8192
    v_max_f32 v37, v37, v38
    ds_read_b64_tr_b16 v[194:195], v24 offset:0
    v_mov_b32 v38, v37
    ds_read_b64_tr_b16 v[196:197], v24 offset:4096
    s_nop 0
    v_permlane32_swap_b32 v37, v38
    ds_read_b64_tr_b16 v[198:199], v24 offset:8192
    v_max_f32 v37, v37, v38
    ds_read_b64_tr_b16 v[200:201], v25 offset:0
    v_mul_f32 v37, s98, v37
    ds_read_b64_tr_b16 v[202:203], v25 offset:4096
    v_fma_f32 v140, v140, s98, -v37
    ds_read_b64_tr_b16 v[204:205], v25 offset:8192
    v_fma_f32 v141, v141, s98, -v37
    ds_read_b64_tr_b16 v[206:207], v26 offset:0
    v_fma_f32 v142, v142, s98, -v37
    ds_read_b64_tr_b16 v[208:209], v26 offset:4096
    v_fma_f32 v143, v143, s98, -v37
    ds_read_b64_tr_b16 v[210:211], v26 offset:8192
    v_fma_f32 v152, v152, s98, -v37
    ds_read_b64_tr_b16 v[212:213], v27 offset:0
    v_fma_f32 v153, v153, s98, -v37
    ds_read_b64_tr_b16 v[214:215], v27 offset:4096
    v_fma_f32 v154, v154, s98, -v37
    ds_read_b64_tr_b16 v[216:217], v27 offset:8192
    v_fma_f32 v155, v155, s98, -v37
    ds_read_b64_tr_b16 v[218:219], v28 offset:0
    v_fma_f32 v164, v164, s98, -v37
    ds_read_b64_tr_b16 v[220:221], v28 offset:4096
    v_fma_f32 v165, v165, s98, -v37
    ds_read_b64_tr_b16 v[222:223], v28 offset:8192
    v_fma_f32 v166, v166, s98, -v37
    s_waitcnt lgkmcnt(15)
    v_mfma_f32_16x16x32_bf16 v[40:43], v[176:179], v[232:235], 0
    v_fma_f32 v167, v167, s98, -v37
    v_exp_f32 v140, v140
    v_exp_f32 v141, v141
    v_exp_f32 v142, v142
    v_mfma_f32_16x16x32_bf16 v[52:55], v[182:185], v[232:235], 0
    v_exp_f32 v143, v143
    v_exp_f32 v152, v152
    v_exp_f32 v153, v153
    v_exp_f32 v154, v154
    v_mfma_f32_16x16x32_bf16 v[64:67], v[188:191], v[232:235], 0
    v_exp_f32 v155, v155
    v_exp_f32 v164, v164
    v_exp_f32 v165, v165
    v_exp_f32 v166, v166
    s_waitcnt lgkmcnt(13)
    v_mfma_f32_16x16x32_bf16 v[76:79], v[194:197], v[232:235], 0
    v_exp_f32 v167, v167
    v_add_f32 v39, v140, v141
    v_add_f32 v38, v142, v143
    v_add_f32 v39, v39, v152
    s_waitcnt lgkmcnt(10)
    v_mfma_f32_16x16x32_bf16 v[88:91], v[200:203], v[232:235], 0
    v_add_f32 v38, v38, v153
    v_add_f32 v39, v39, v154
    v_add_f32 v38, v38, v155
    v_add_f32 v39, v39, v164
    s_waitcnt lgkmcnt(7)
    v_mfma_f32_16x16x32_bf16 v[100:103], v[206:209], v[232:235], 0
    v_add_f32 v38, v38, v165
    v_add_f32 v39, v39, v166
    v_add_f32 v38, v38, v167
    v_add_f32 v39, v39, v38
    s_waitcnt lgkmcnt(4)
    v_mfma_f32_16x16x32_bf16 v[112:115], v[212:215], v[232:235], 0
    v_mov_b32 v38, v39
    s_nop 1
    v_permlane16_swap_b32 v39, v38
    v_add_f32 v39, v39, v38
    v_mov_b32 v38, v39
    s_waitcnt lgkmcnt(1)
    v_mfma_f32_16x16x32_bf16 v[124:127], v[218:221], v[232:235], 0
    v_permlane32_swap_b32 v39, v38
    v_add_f32 v39, v39, v38
    v_rcp_f32 v39, v39
    s_nop 0
    v_mul_f32 v140, v140, v39
    v_mfma_f32_16x16x16_bf16 v[40:43], v[180:181], v[236:237], v[40:43]
    v_mul_f32 v141, v141, v39
    v_mul_f32 v142, v142, v39
    v_mul_f32 v143, v143, v39
    v_mul_f32 v152, v152, v39
    v_mfma_f32_16x16x16_bf16 v[52:55], v[186:187], v[236:237], v[52:55]
    v_mul_f32 v153, v153, v39
    v_mul_f32 v154, v154, v39
    v_mul_f32 v155, v155, v39
    v_mul_f32 v164, v164, v39
    v_mfma_f32_16x16x16_bf16 v[64:67], v[192:193], v[236:237], v[64:67]
    v_mul_f32 v165, v165, v39
    v_mul_f32 v166, v166, v39
    v_mul_f32 v167, v167, v39
    v_cvt_pk_bf16_f32 v240, v140, v141
    v_mfma_f32_16x16x16_bf16 v[76:79], v[198:199], v[236:237], v[76:79]
    v_cvt_pk_bf16_f32 v241, v142, v143
    v_cvt_pk_bf16_f32 v242, v152, v153
    v_cvt_pk_bf16_f32 v243, v154, v155
    v_cvt_pk_bf16_f32 v244, v164, v165
    v_mfma_f32_16x16x16_bf16 v[88:91], v[204:205], v[236:237], v[88:91]
    v_cvt_pk_bf16_f32 v245, v166, v167
    v_mfma_f32_16x16x16_bf16 v[100:103], v[210:211], v[236:237], v[100:103]
    v_mfma_f32_16x16x16_bf16 v[112:115], v[216:217], v[236:237], v[112:115]
    s_waitcnt lgkmcnt(0)
    v_mfma_f32_16x16x16_bf16 v[124:127], v[222:223], v[236:237], v[124:127]
    v_mfma_f32_16x16x32_bf16 v[44:47], v[176:179], v[240:243], 0
    v_max3_f32 v37, v144, v145, v146
    v_max3_f32 v38, v147, v156, v157
    v_max3_f32 v37, v37, v158, v159
    v_max3_f32 v38, v38, v168, v169
    v_max3_f32 v37, v37, v170, v171
    v_mfma_f32_16x16x32_bf16 v[56:59], v[182:185], v[240:243], 0
    v_max_f32 v37, v37, v38
    v_mov_b32 v38, v37
    s_nop 1
    v_permlane16_swap_b32 v37, v38
    v_max_f32 v37, v37, v38
    v_mov_b32 v38, v37
    v_mfma_f32_16x16x32_bf16 v[68:71], v[188:191], v[240:243], 0
    s_nop 0
    v_permlane32_swap_b32 v37, v38
    v_max_f32 v37, v37, v38
    v_mul_f32 v37, s98, v37
    v_fma_f32 v144, v144, s98, -v37
    v_fma_f32 v145, v145, s98, -v37
    v_mfma_f32_16x16x32_bf16 v[80:83], v[194:197], v[240:243], 0
    v_fma_f32 v146, v146, s98, -v37
    v_fma_f32 v147, v147, s98, -v37
    v_fma_f32 v156, v156, s98, -v37
    v_fma_f32 v157, v157, s98, -v37
    v_fma_f32 v158, v158, s98, -v37
    v_mfma_f32_16x16x32_bf16 v[92:95], v[200:203], v[240:243], 0
    v_fma_f32 v159, v159, s98, -v37
    v_fma_f32 v168, v168, s98, -v37
    v_fma_f32 v169, v169, s98, -v37
    v_fma_f32 v170, v170, s98, -v37
    v_fma_f32 v171, v171, s98, -v37
    v_mfma_f32_16x16x32_bf16 v[104:107], v[206:209], v[240:243], 0
    v_exp_f32 v144, v144
    v_exp_f32 v145, v145
    v_exp_f32 v146, v146
    v_exp_f32 v147, v147
    v_exp_f32 v156, v156
    v_mfma_f32_16x16x32_bf16 v[116:119], v[212:215], v[240:243], 0
    v_exp_f32 v157, v157
    v_exp_f32 v158, v158
    v_exp_f32 v159, v159
    v_exp_f32 v168, v168
    v_exp_f32 v169, v169
    v_mfma_f32_16x16x32_bf16 v[128:131], v[218:221], v[240:243], 0
    v_exp_f32 v170, v170
    v_exp_f32 v171, v171
    v_add_f32 v39, v144, v145
    v_add_f32 v38, v146, v147
    v_add_f32 v39, v39, v156
    v_mfma_f32_16x16x16_bf16 v[44:47], v[180:181], v[244:245], v[44:47]
    v_add_f32 v38, v38, v157
    v_add_f32 v39, v39, v158
    v_add_f32 v38, v38, v159
    v_add_f32 v39, v39, v168
    v_add_f32 v38, v38, v169
    v_mfma_f32_16x16x16_bf16 v[56:59], v[186:187], v[244:245], v[56:59]
    v_add_f32 v39, v39, v170
    v_add_f32 v38, v38, v171
    v_add_f32 v39, v39, v38
    v_mov_b32 v38, v39
    s_nop 1
    v_permlane16_swap_b32 v39, v38
    v_mfma_f32_16x16x16_bf16 v[68:71], v[192:193], v[244:245], v[68:71]
    v_add_f32 v39, v39, v38
    v_mov_b32 v38, v39
    s_nop 1
    v_permlane32_swap_b32 v39, v38
    v_add_f32 v39, v39, v38
    v_rcp_f32 v39, v39
    v_mfma_f32_16x16x16_bf16 v[80:83], v[198:199], v[244:245], v[80:83]
    v_mul_f32 v144, v144, v39
    v_mul_f32 v145, v145, v39
    v_mul_f32 v146, v146, v39
    v_mul_f32 v147, v147, v39
    v_mul_f32 v156, v156, v39
    v_mfma_f32_16x16x16_bf16 v[92:95], v[204:205], v[244:245], v[92:95]
    v_mul_f32 v157, v157, v39
    v_mul_f32 v158, v158, v39
    v_mul_f32 v159, v159, v39
    v_mul_f32 v168, v168, v39
    v_mul_f32 v169, v169, v39
    v_mfma_f32_16x16x16_bf16 v[104:107], v[210:211], v[244:245], v[104:107]
    v_mul_f32 v170, v170, v39
    v_mul_f32 v171, v171, v39
    v_cvt_pk_bf16_f32 v248, v144, v145
    v_cvt_pk_bf16_f32 v249, v146, v147
    v_cvt_pk_bf16_f32 v250, v156, v157
    v_mfma_f32_16x16x16_bf16 v[116:119], v[216:217], v[244:245], v[116:119]
    v_cvt_pk_bf16_f32 v251, v158, v159
    v_cvt_pk_bf16_f32 v252, v168, v169
    v_cvt_pk_bf16_f32 v253, v170, v171
    v_mfma_f32_16x16x16_bf16 v[128:131], v[222:223], v[244:245], v[128:131]
    v_cvt_pk_bf16_f32 v40, v40, v41
    v_cvt_pk_bf16_f32 v41, v42, v43
    v_cvt_pk_bf16_f32 v42, v52, v53
    v_cvt_pk_bf16_f32 v43, v54, v55
    buffer_store_dwordx4 v[40:43], v10, s[56:59], s24 offen offset:0 sc0 sc1
    v_cvt_pk_bf16_f32 v64, v64, v65
    v_cvt_pk_bf16_f32 v65, v66, v67
    v_cvt_pk_bf16_f32 v66, v76, v77
    v_cvt_pk_bf16_f32 v67, v78, v79
    buffer_store_dwordx4 v[64:67], v10, s[56:59], s24 offen offset:1024 sc0 sc1
    v_cvt_pk_bf16_f32 v88, v88, v89
    v_cvt_pk_bf16_f32 v89, v90, v91
    v_cvt_pk_bf16_f32 v90, v100, v101
    v_cvt_pk_bf16_f32 v91, v102, v103
    buffer_store_dwordx4 v[88:91], v10, s[56:59], s24 offen offset:2048 sc0 sc1
    v_cvt_pk_bf16_f32 v112, v112, v113
    v_cvt_pk_bf16_f32 v113, v114, v115
    v_cvt_pk_bf16_f32 v114, v124, v125
    v_cvt_pk_bf16_f32 v115, v126, v127
    buffer_store_dwordx4 v[112:115], v10, s[56:59], s24 offen offset:3072 sc0 sc1
    v_mfma_f32_16x16x32_bf16 v[48:51], v[176:179], v[248:251], 0
    v_cvt_pk_bf16_f32 v44, v44, v45
    v_cvt_pk_bf16_f32 v45, v46, v47
    v_mfma_f32_16x16x32_bf16 v[60:63], v[182:185], v[248:251], 0
    v_cvt_pk_bf16_f32 v46, v56, v57
    v_cvt_pk_bf16_f32 v47, v58, v59
    v_mfma_f32_16x16x32_bf16 v[72:75], v[188:191], v[248:251], 0
    buffer_store_dwordx4 v[44:47], v10, s[56:59], s25 offen offset:0 sc0 sc1
    v_cvt_pk_bf16_f32 v68, v68, v69
    v_mfma_f32_16x16x32_bf16 v[84:87], v[194:197], v[248:251], 0
    v_cvt_pk_bf16_f32 v69, v70, v71
    v_cvt_pk_bf16_f32 v70, v80, v81
    v_mfma_f32_16x16x32_bf16 v[96:99], v[200:203], v[248:251], 0
    v_cvt_pk_bf16_f32 v71, v82, v83
    buffer_store_dwordx4 v[68:71], v10, s[56:59], s25 offen offset:1024 sc0 sc1
    v_mfma_f32_16x16x32_bf16 v[108:111], v[206:209], v[248:251], 0
    v_cvt_pk_bf16_f32 v92, v92, v93
    v_cvt_pk_bf16_f32 v93, v94, v95
    v_mfma_f32_16x16x32_bf16 v[120:123], v[212:215], v[248:251], 0
    v_cvt_pk_bf16_f32 v94, v104, v105
    v_cvt_pk_bf16_f32 v95, v106, v107
    v_mfma_f32_16x16x32_bf16 v[132:135], v[218:221], v[248:251], 0
    buffer_store_dwordx4 v[92:95], v10, s[56:59], s25 offen offset:2048 sc0 sc1
    v_cvt_pk_bf16_f32 v116, v116, v117
    v_mfma_f32_16x16x16_bf16 v[48:51], v[180:181], v[252:253], v[48:51]
    v_cvt_pk_bf16_f32 v117, v118, v119
    v_cvt_pk_bf16_f32 v118, v128, v129
    v_mfma_f32_16x16x16_bf16 v[60:63], v[186:187], v[252:253], v[60:63]
    v_cvt_pk_bf16_f32 v119, v130, v131
    buffer_store_dwordx4 v[116:119], v10, s[56:59], s25 offen offset:3072 sc0 sc1
    v_mfma_f32_16x16x16_bf16 v[72:75], v[192:193], v[252:253], v[72:75]
    v_mfma_f32_16x16x16_bf16 v[84:87], v[198:199], v[252:253], v[84:87]
    v_mfma_f32_16x16x16_bf16 v[96:99], v[204:205], v[252:253], v[96:99]
    v_mfma_f32_16x16x16_bf16 v[108:111], v[210:211], v[252:253], v[108:111]
    v_mfma_f32_16x16x16_bf16 v[120:123], v[216:217], v[252:253], v[120:123]
    v_mfma_f32_16x16x16_bf16 v[132:135], v[222:223], v[252:253], v[132:135]
    v_cvt_pk_bf16_f32 v48, v48, v49
    v_cvt_pk_bf16_f32 v49, v50, v51
    v_cvt_pk_bf16_f32 v50, v60, v61
    v_cvt_pk_bf16_f32 v51, v62, v63
    buffer_store_dwordx4 v[48:51], v10, s[56:59], s26 offen offset:0 sc0 sc1
    v_cvt_pk_bf16_f32 v72, v72, v73
    v_cvt_pk_bf16_f32 v73, v74, v75
    v_cvt_pk_bf16_f32 v74, v84, v85
    v_cvt_pk_bf16_f32 v75, v86, v87
    buffer_store_dwordx4 v[72:75], v10, s[56:59], s26 offen offset:1024 sc0 sc1
    v_cvt_pk_bf16_f32 v96, v96, v97
    v_cvt_pk_bf16_f32 v97, v98, v99
    v_cvt_pk_bf16_f32 v98, v108, v109
    v_cvt_pk_bf16_f32 v99, v110, v111
    buffer_store_dwordx4 v[96:99], v10, s[56:59], s26 offen offset:2048 sc0 sc1
    v_cvt_pk_bf16_f32 v120, v120, v121
    v_cvt_pk_bf16_f32 v121, v122, v123
    v_cvt_pk_bf16_f32 v122, v132, v133
    v_cvt_pk_bf16_f32 v123, v134, v135
    buffer_store_dwordx4 v[120:123], v10, s[56:59], s26 offen offset:3072 sc0 sc1
    s_endpgm
L_loader_k1:
    s_cmp_ge_u32 s79, 6
    s_cbranch_scc1 L_kv
    s_and_b32 s23, s79, 1
    v_lshlrev_b32 v7, 1, v2
    v_xor_b32 v7, v7, v3
    v_lshlrev_b32 v7, 4, v7
    v_lshl_add_u32 v11, v2, 13, v7
    v_xor_b32 v12, 0x80, v11
    v_lshrrev_b32 v7, 3, v1
    v_mul_u32_u24 v7, 1280, v7
    v_and_b32 v8, 7, v1
    v_xor_b32 v8, v8, v2
    v_lshl_add_u32 v13, v8, 4, v7
    v_xor_b32 v8, 4, v8
    v_lshl_add_u32 v14, v8, 4, v7
    s_lshl_b32 s24, s16, 8
    s_lshl_b32 s10, s23, 18
    s_add_u32 s24, s24, s10
    s_lshl_b32 s25, s23, 13
    s_lshl_b32 s22, s9, 2
    s_lshl_b32 s10, s23, 1
    s_add_u32 s22, s22, s10
    s_mul_i32 s26, s22, 61440
    s_mul_i32 s77, s23, 49152
    s_add_u32 s77, s77, 65536
    s_mul_i32 s10, s9, 5
    s_lshr_b32 s10, s10, 1
    s_mul_i32 s11, s8, 5
    s_lshr_b32 s11, s11, 2
    s_add_u32 s72, s10, s11
    s_cmp_ge_u32 s72, 10
    s_cselect_b32 s10, 10, 0
    s_sub_u32 s72, s72, s10
    s_lshl_b32 s10, s2, 7
    s_add_u32 s10, s10, 50331648
    v_mov_b32 v16, 0
    buffer_store_dword v16, v16, s[56:59], s10 offen
    s_lshl_b32 s73, s72, 19
    s_add_u32 s73, s73, s24
    s_lshl_b32 s74, s72, 7
    s_add_u32 s74, s74, s26
    s_add_u32 m0, s25, 0
    s_add_u32 s97, s73, 0
    buffer_load_dwordx4 v11, s[52:55], s97 offen lds
    s_add_u32 m0, s25, 1024
    s_add_u32 s97, s73, 32768
    buffer_load_dwordx4 v11, s[52:55], s97 offen lds
    s_add_u32 m0, s25, 2048
    s_add_u32 s97, s73, 65536
    buffer_load_dwordx4 v12, s[52:55], s97 offen lds
    s_add_u32 m0, s25, 3072
    s_add_u32 s97, s73, 98304
    buffer_load_dwordx4 v12, s[52:55], s97 offen lds
    s_add_u32 m0, s25, 4096
    s_add_u32 s97, s73, 131072
    buffer_load_dwordx4 v11, s[52:55], s97 offen lds
    s_add_u32 m0, s25, 5120
    s_add_u32 s97, s73, 163840
    buffer_load_dwordx4 v11, s[52:55], s97 offen lds
    s_add_u32 m0, s25, 6144
    s_add_u32 s97, s73, 196608
    buffer_load_dwordx4 v12, s[52:55], s97 offen lds
    s_add_u32 m0, s25, 7168
    s_add_u32 s97, s73, 229376
    buffer_load_dwordx4 v12, s[52:55], s97 offen lds
    s_add_u32 m0, s77, 0
    s_add_u32 s97, s74, 0
    buffer_load_dwordx4 v13, s[40:43], s97 offen lds
    s_add_u32 m0, s77, 1024
    s_add_u32 s97, s74, 10240
    buffer_load_dwordx4 v14, s[40:43], s97 offen lds
    s_add_u32 m0, s77, 2048
    s_add_u32 s97, s74, 20480
    buffer_load_dwordx4 v13, s[40:43], s97 offen lds
    s_add_u32 m0, s77, 3072
    s_add_u32 s97, s74, 30720
    buffer_load_dwordx4 v14, s[40:43], s97 offen lds
    s_add_u32 m0, s77, 4096
    s_add_u32 s97, s74, 40960
    buffer_load_dwordx4 v13, s[40:43], s97 offen lds
    s_add_u32 m0, s77, 5120
    s_add_u32 s97, s74, 51200
    buffer_load_dwordx4 v14, s[40:43], s97 offen lds
    s_add_u32 m0, s77, 24576
    s_add_u32 s97, s74, 61440
    buffer_load_dwordx4 v13, s[40:43], s97 offen lds
    s_add_u32 m0, s77, 25600
    s_add_u32 s97, s74, 71680
    buffer_load_dwordx4 v14, s[40:43], s97 offen lds
    s_add_u32 m0, s77, 26624
    s_add_u32 s97, s74, 81920
    buffer_load_dwordx4 v13, s[40:43], s97 offen lds
    s_add_u32 m0, s77, 27648
    s_add_u32 s97, s74, 92160
    buffer_load_dwordx4 v14, s[40:43], s97 offen lds
    s_add_u32 m0, s77, 28672
    s_add_u32 s97, s74, 102400
    buffer_load_dwordx4 v13, s[40:43], s97 offen lds
    s_add_u32 m0, s77, 29696
    s_add_u32 s97, s74, 112640
    buffer_load_dwordx4 v14, s[40:43], s97 offen lds
    s_add_u32 s72, s72, 1
    s_cmp_ge_u32 s72, 10
    s_cselect_b32 s10, 10, 0
    s_sub_u32 s72, s72, s10
    s_lshl_b32 s73, s72, 19
    s_add_u32 s73, s73, s24
    s_lshl_b32 s74, s72, 7
    s_add_u32 s74, s74, s26
    s_add_u32 m0, s25, 16384
    s_add_u32 s97, s73, 0
    buffer_load_dwordx4 v11, s[52:55], s97 offen lds
    s_add_u32 m0, s25, 17408
    s_add_u32 s97, s73, 32768
    buffer_load_dwordx4 v11, s[52:55], s97 offen lds
    s_add_u32 m0, s25, 18432
    s_add_u32 s97, s73, 65536
    buffer_load_dwordx4 v12, s[52:55], s97 offen lds
    s_add_u32 m0, s25, 19456
    s_add_u32 s97, s73, 98304
    buffer_load_dwordx4 v12, s[52:55], s97 offen lds
    s_add_u32 m0, s25, 20480
    s_add_u32 s97, s73, 131072
    buffer_load_dwordx4 v11, s[52:55], s97 offen lds
    s_add_u32 m0, s25, 21504
    s_add_u32 s97, s73, 163840
    buffer_load_dwordx4 v11, s[52:55], s97 offen lds
    s_add_u32 m0, s25, 22528
    s_add_u32 s97, s73, 196608
    buffer_load_dwordx4 v12, s[52:55], s97 offen lds
    s_add_u32 m0, s25, 23552
    s_add_u32 s97, s73, 229376
    buffer_load_dwordx4 v12, s[52:55], s97 offen lds
    s_add_u32 m0, s77, 6144
    s_add_u32 s97, s74, 0
    buffer_load_dwordx4 v13, s[40:43], s97 offen lds
    s_add_u32 m0, s77, 7168
    s_add_u32 s97, s74, 10240
    buffer_load_dwordx4 v14, s[40:43], s97 offen lds
    s_add_u32 m0, s77, 8192
    s_add_u32 s97, s74, 20480
    buffer_load_dwordx4 v13, s[40:43], s97 offen lds
    s_add_u32 m0, s77, 9216
    s_add_u32 s97, s74, 30720
    buffer_load_dwordx4 v14, s[40:43], s97 offen lds
    s_add_u32 m0, s77, 10240
    s_add_u32 s97, s74, 40960
    buffer_load_dwordx4 v13, s[40:43], s97 offen lds
    s_add_u32 m0, s77, 11264
    s_add_u32 s97, s74, 51200
    buffer_load_dwordx4 v14, s[40:43], s97 offen lds
    s_add_u32 m0, s77, 30720
    s_add_u32 s97, s74, 61440
    buffer_load_dwordx4 v13, s[40:43], s97 offen lds
    s_add_u32 m0, s77, 31744
    s_add_u32 s97, s74, 71680
    buffer_load_dwordx4 v14, s[40:43], s97 offen lds
    s_add_u32 m0, s77, 32768
    s_add_u32 s97, s74, 81920
    buffer_load_dwordx4 v13, s[40:43], s97 offen lds
    s_add_u32 m0, s77, 33792
    s_add_u32 s97, s74, 92160
    buffer_load_dwordx4 v14, s[40:43], s97 offen lds
    s_add_u32 m0, s77, 34816
    s_add_u32 s97, s74, 102400
    buffer_load_dwordx4 v13, s[40:43], s97 offen lds
    s_add_u32 m0, s77, 35840
    s_add_u32 s97, s74, 112640
    buffer_load_dwordx4 v14, s[40:43], s97 offen lds
    s_waitcnt vmcnt(20)
    s_barrier
    s_add_u32 s72, s72, 1
    s_cmp_ge_u32 s72, 10
    s_cselect_b32 s10, 10, 0
    s_sub_u32 s72, s72, s10
    s_lshl_b32 s73, s72, 19
    s_add_u32 s73, s73, s24
    s_lshl_b32 s74, s72, 7
    s_add_u32 s74, s74, s26
    s_add_u32 m0, s25, 32768
    s_add_u32 s97, s73, 0
    buffer_load_dwordx4 v11, s[52:55], s97 offen lds
    s_add_u32 m0, s25, 33792
    s_add_u32 s97, s73, 32768
    buffer_load_dwordx4 v11, s[52:55], s97 offen lds
    s_add_u32 m0, s25, 34816
    s_add_u32 s97, s73, 65536
    buffer_load_dwordx4 v12, s[52:55], s97 offen lds
    s_add_u32 m0, s25, 35840
    s_add_u32 s97, s73, 98304
    buffer_load_dwordx4 v12, s[52:55], s97 offen lds
    s_add_u32 m0, s25, 36864
    s_add_u32 s97, s73, 131072
    buffer_load_dwordx4 v11, s[52:55], s97 offen lds
    s_add_u32 m0, s25, 37888
    s_add_u32 s97, s73, 163840
    buffer_load_dwordx4 v11, s[52:55], s97 offen lds
    s_add_u32 m0, s25, 38912
    s_add_u32 s97, s73, 196608
    buffer_load_dwordx4 v12, s[52:55], s97 offen lds
    s_add_u32 m0, s25, 39936
    s_add_u32 s97, s73, 229376
    buffer_load_dwordx4 v12, s[52:55], s97 offen lds
    s_add_u32 m0, s77, 12288
    s_add_u32 s97, s74, 0
    buffer_load_dwordx4 v13, s[40:43], s97 offen lds
    s_add_u32 m0, s77, 13312
    s_add_u32 s97, s74, 10240
    buffer_load_dwordx4 v14, s[40:43], s97 offen lds
    s_add_u32 m0, s77, 14336
    s_add_u32 s97, s74, 20480
    buffer_load_dwordx4 v13, s[40:43], s97 offen lds
    s_add_u32 m0, s77, 15360
    s_add_u32 s97, s74, 30720
    buffer_load_dwordx4 v14, s[40:43], s97 offen lds
    s_add_u32 m0, s77, 16384
    s_add_u32 s97, s74, 40960
    buffer_load_dwordx4 v13, s[40:43], s97 offen lds
    s_add_u32 m0, s77, 17408
    s_add_u32 s97, s74, 51200
    buffer_load_dwordx4 v14, s[40:43], s97 offen lds
    s_add_u32 m0, s77, 36864
    s_add_u32 s97, s74, 61440
    buffer_load_dwordx4 v13, s[40:43], s97 offen lds
    s_add_u32 m0, s77, 37888
    s_add_u32 s97, s74, 71680
    buffer_load_dwordx4 v14, s[40:43], s97 offen lds
    s_add_u32 m0, s77, 38912
    s_add_u32 s97, s74, 81920
    buffer_load_dwordx4 v13, s[40:43], s97 offen lds
    s_add_u32 m0, s77, 39936
    s_add_u32 s97, s74, 92160
    buffer_load_dwordx4 v14, s[40:43], s97 offen lds
    s_add_u32 m0, s77, 40960
    s_add_u32 s97, s74, 102400
    buffer_load_dwordx4 v13, s[40:43], s97 offen lds
    s_add_u32 m0, s77, 41984
    s_add_u32 s97, s74, 112640
    buffer_load_dwordx4 v14, s[40:43], s97 offen lds
    s_waitcnt vmcnt(20)
    s_barrier
    s_add_u32 s72, s72, 1
    s_cmp_ge_u32 s72, 10
    s_cselect_b32 s10, 10, 0
    s_sub_u32 s72, s72, s10
    s_lshl_b32 s73, s72, 19
    s_add_u32 s73, s73, s24
    s_lshl_b32 s74, s72, 7
    s_add_u32 s74, s74, s26
    s_add_u32 m0, s25, 49152
    s_add_u32 s97, s73, 0
    buffer_load_dwordx4 v11, s[52:55], s97 offen lds
    s_add_u32 m0, s25, 50176
    s_add_u32 s97, s73, 32768
    buffer_load_dwordx4 v11, s[52:55], s97 offen lds
    s_add_u32 m0, s25, 51200
    s_add_u32 s97, s73, 65536
    buffer_load_dwordx4 v12, s[52:55], s97 offen lds
    s_add_u32 m0, s25, 52224
    s_add_u32 s97, s73, 98304
    buffer_load_dwordx4 v12, s[52:55], s97 offen lds
    s_add_u32 m0, s25, 53248
    s_add_u32 s97, s73, 131072
    buffer_load_dwordx4 v11, s[52:55], s97 offen lds
    s_add_u32 m0, s25, 54272
    s_add_u32 s97, s73, 163840
    buffer_load_dwordx4 v11, s[52:55], s97 offen lds
    s_add_u32 m0, s25, 55296
    s_add_u32 s97, s73, 196608
    buffer_load_dwordx4 v12, s[52:55], s97 offen lds
    s_add_u32 m0, s25, 56320
    s_add_u32 s97, s73, 229376
    buffer_load_dwordx4 v12, s[52:55], s97 offen lds
    s_add_u32 m0, s77, 18432
    s_add_u32 s97, s74, 0
    buffer_load_dwordx4 v13, s[40:43], s97 offen lds
    s_add_u32 m0, s77, 19456
    s_add_u32 s97, s74, 10240
    buffer_load_dwordx4 v14, s[40:43], s97 offen lds
    s_add_u32 m0, s77, 20480
    s_add_u32 s97, s74, 20480
    buffer_load_dwordx4 v13, s[40:43], s97 offen lds
    s_add_u32 m0, s77, 21504
    s_add_u32 s97, s74, 30720
    buffer_load_dwordx4 v14, s[40:43], s97 offen lds
    s_add_u32 m0, s77, 22528
    s_add_u32 s97, s74, 40960
    buffer_load_dwordx4 v13, s[40:43], s97 offen lds
    s_add_u32 m0, s77, 23552
    s_add_u32 s97, s74, 51200
    buffer_load_dwordx4 v14, s[40:43], s97 offen lds
    s_add_u32 m0, s77, 43008
    s_add_u32 s97, s74, 61440
    buffer_load_dwordx4 v13, s[40:43], s97 offen lds
    s_add_u32 m0, s77, 44032
    s_add_u32 s97, s74, 71680
    buffer_load_dwordx4 v14, s[40:43], s97 offen lds
    s_add_u32 m0, s77, 45056
    s_add_u32 s97, s74, 81920
    buffer_load_dwordx4 v13, s[40:43], s97 offen lds
    s_add_u32 m0, s77, 46080
    s_add_u32 s97, s74, 92160
    buffer_load_dwordx4 v14, s[40:43], s97 offen lds
    s_add_u32 m0, s77, 47104
    s_add_u32 s97, s74, 102400
    buffer_load_dwordx4 v13, s[40:43], s97 offen lds
    s_add_u32 m0, s77, 48128
    s_add_u32 s97, s74, 112640
    buffer_load_dwordx4 v14, s[40:43], s97 offen lds
    s_waitcnt vmcnt(20)
    s_barrier
    s_add_u32 s72, s72, 1
    s_cmp_ge_u32 s72, 10
    s_cselect_b32 s10, 10, 0
    s_sub_u32 s72, s72, s10
    s_lshl_b32 s73, s72, 19
    s_add_u32 s73, s73, s24
    s_lshl_b32 s74, s72, 7
    s_add_u32 s74, s74, s26
    s_add_u32 m0, s25, 0
    s_add_u32 s97, s73, 0
    buffer_load_dwordx4 v11, s[52:55], s97 offen lds
    s_add_u32 m0, s25, 1024
    s_add_u32 s97, s73, 32768
    buffer_load_dwordx4 v11, s[52:55], s97 offen lds
    s_add_u32 m0, s25, 2048
    s_add_u32 s97, s73, 65536
    buffer_load_dwordx4 v12, s[52:55], s97 offen lds
    s_add_u32 m0, s25, 3072
    s_add_u32 s97, s73, 98304
    buffer_load_dwordx4 v12, s[52:55], s97 offen lds
    s_add_u32 m0, s25, 4096
    s_add_u32 s97, s73, 131072
    buffer_load_dwordx4 v11, s[52:55], s97 offen lds
    s_add_u32 m0, s25, 5120
    s_add_u32 s97, s73, 163840
    buffer_load_dwordx4 v11, s[52:55], s97 offen lds
    s_add_u32 m0, s25, 6144
    s_add_u32 s97, s73, 196608
    buffer_load_dwordx4 v12, s[52:55], s97 offen lds
    s_add_u32 m0, s25, 7168
    s_add_u32 s97, s73, 229376
    buffer_load_dwordx4 v12, s[52:55], s97 offen lds
    s_add_u32 m0, s77, 0
    s_add_u32 s97, s74, 0
    buffer_load_dwordx4 v13, s[40:43], s97 offen lds
    s_add_u32 m0, s77, 1024
    s_add_u32 s97, s74, 10240
    buffer_load_dwordx4 v14, s[40:43], s97 offen lds
    s_add_u32 m0, s77, 2048
    s_add_u32 s97, s74, 20480
    buffer_load_dwordx4 v13, s[40:43], s97 offen lds
    s_add_u32 m0, s77, 3072
    s_add_u32 s97, s74, 30720
    buffer_load_dwordx4 v14, s[40:43], s97 offen lds
    s_add_u32 m0, s77, 4096
    s_add_u32 s97, s74, 40960
    buffer_load_dwordx4 v13, s[40:43], s97 offen lds
    s_add_u32 m0, s77, 5120
    s_add_u32 s97, s74, 51200
    buffer_load_dwordx4 v14, s[40:43], s97 offen lds
    s_add_u32 m0, s77, 24576
    s_add_u32 s97, s74, 61440
    buffer_load_dwordx4 v13, s[40:43], s97 offen lds
    s_add_u32 m0, s77, 25600
    s_add_u32 s97, s74, 71680
    buffer_load_dwordx4 v14, s[40:43], s97 offen lds
    s_add_u32 m0, s77, 26624
    s_add_u32 s97, s74, 81920
    buffer_load_dwordx4 v13, s[40:43], s97 offen lds
    s_add_u32 m0, s77, 27648
    s_add_u32 s97, s74, 92160
    buffer_load_dwordx4 v14, s[40:43], s97 offen lds
    s_add_u32 m0, s77, 28672
    s_add_u32 s97, s74, 102400
    buffer_load_dwordx4 v13, s[40:43], s97 offen lds
    s_add_u32 m0, s77, 29696
    s_add_u32 s97, s74, 112640
    buffer_load_dwordx4 v14, s[40:43], s97 offen lds
    s_waitcnt vmcnt(20)
    s_barrier
    s_add_u32 s72, s72, 1
    s_cmp_ge_u32 s72, 10
    s_cselect_b32 s10, 10, 0
    s_sub_u32 s72, s72, s10
    s_lshl_b32 s73, s72, 19
    s_add_u32 s73, s73, s24
    s_lshl_b32 s74, s72, 7
    s_add_u32 s74, s74, s26
    s_add_u32 m0, s25, 16384
    s_add_u32 s97, s73, 0
    buffer_load_dwordx4 v11, s[52:55], s97 offen lds
    s_add_u32 m0, s25, 17408
    s_add_u32 s97, s73, 32768
    buffer_load_dwordx4 v11, s[52:55], s97 offen lds
    s_add_u32 m0, s25, 18432
    s_add_u32 s97, s73, 65536
    buffer_load_dwordx4 v12, s[52:55], s97 offen lds
    s_add_u32 m0, s25, 19456
    s_add_u32 s97, s73, 98304
    buffer_load_dwordx4 v12, s[52:55], s97 offen lds
    s_add_u32 m0, s25, 20480
    s_add_u32 s97, s73, 131072
    buffer_load_dwordx4 v11, s[52:55], s97 offen lds
    s_add_u32 m0, s25, 21504
    s_add_u32 s97, s73, 163840
    buffer_load_dwordx4 v11, s[52:55], s97 offen lds
    s_add_u32 m0, s25, 22528
    s_add_u32 s97, s73, 196608
    buffer_load_dwordx4 v12, s[52:55], s97 offen lds
    s_add_u32 m0, s25, 23552
    s_add_u32 s97, s73, 229376
    buffer_load_dwordx4 v12, s[52:55], s97 offen lds
    s_add_u32 m0, s77, 6144
    s_add_u32 s97, s74, 0
    buffer_load_dwordx4 v13, s[40:43], s97 offen lds
    s_add_u32 m0, s77, 7168
    s_add_u32 s97, s74, 10240
    buffer_load_dwordx4 v14, s[40:43], s97 offen lds
    s_add_u32 m0, s77, 8192
    s_add_u32 s97, s74, 20480
    buffer_load_dwordx4 v13, s[40:43], s97 offen lds
    s_add_u32 m0, s77, 9216
    s_add_u32 s97, s74, 30720
    buffer_load_dwordx4 v14, s[40:43], s97 offen lds
    s_add_u32 m0, s77, 10240
    s_add_u32 s97, s74, 40960
    buffer_load_dwordx4 v13, s[40:43], s97 offen lds
    s_add_u32 m0, s77, 11264
    s_add_u32 s97, s74, 51200
    buffer_load_dwordx4 v14, s[40:43], s97 offen lds
    s_add_u32 m0, s77, 30720
    s_add_u32 s97, s74, 61440
    buffer_load_dwordx4 v13, s[40:43], s97 offen lds
    s_add_u32 m0, s77, 31744
    s_add_u32 s97, s74, 71680
    buffer_load_dwordx4 v14, s[40:43], s97 offen lds
    s_add_u32 m0, s77, 32768
    s_add_u32 s97, s74, 81920
    buffer_load_dwordx4 v13, s[40:43], s97 offen lds
    s_add_u32 m0, s77, 33792
    s_add_u32 s97, s74, 92160
    buffer_load_dwordx4 v14, s[40:43], s97 offen lds
    s_add_u32 m0, s77, 34816
    s_add_u32 s97, s74, 102400
    buffer_load_dwordx4 v13, s[40:43], s97 offen lds
    s_add_u32 m0, s77, 35840
    s_add_u32 s97, s74, 112640
    buffer_load_dwordx4 v14, s[40:43], s97 offen lds
    s_waitcnt vmcnt(20)
    s_barrier
    s_add_u32 s72, s72, 1
    s_cmp_ge_u32 s72, 10
    s_cselect_b32 s10, 10, 0
    s_sub_u32 s72, s72, s10
    s_lshl_b32 s73, s72, 19
    s_add_u32 s73, s73, s24
    s_lshl_b32 s74, s72, 7
    s_add_u32 s74, s74, s26
    s_add_u32 m0, s25, 32768
    s_add_u32 s97, s73, 0
    buffer_load_dwordx4 v11, s[52:55], s97 offen lds
    s_add_u32 m0, s25, 33792
    s_add_u32 s97, s73, 32768
    buffer_load_dwordx4 v11, s[52:55], s97 offen lds
    s_add_u32 m0, s25, 34816
    s_add_u32 s97, s73, 65536
    buffer_load_dwordx4 v12, s[52:55], s97 offen lds
    s_add_u32 m0, s25, 35840
    s_add_u32 s97, s73, 98304
    buffer_load_dwordx4 v12, s[52:55], s97 offen lds
    s_add_u32 m0, s25, 36864
    s_add_u32 s97, s73, 131072
    buffer_load_dwordx4 v11, s[52:55], s97 offen lds
    s_add_u32 m0, s25, 37888
    s_add_u32 s97, s73, 163840
    buffer_load_dwordx4 v11, s[52:55], s97 offen lds
    s_add_u32 m0, s25, 38912
    s_add_u32 s97, s73, 196608
    buffer_load_dwordx4 v12, s[52:55], s97 offen lds
    s_add_u32 m0, s25, 39936
    s_add_u32 s97, s73, 229376
    buffer_load_dwordx4 v12, s[52:55], s97 offen lds
    s_add_u32 m0, s77, 12288
    s_add_u32 s97, s74, 0
    buffer_load_dwordx4 v13, s[40:43], s97 offen lds
    s_add_u32 m0, s77, 13312
    s_add_u32 s97, s74, 10240
    buffer_load_dwordx4 v14, s[40:43], s97 offen lds
    s_add_u32 m0, s77, 14336
    s_add_u32 s97, s74, 20480
    buffer_load_dwordx4 v13, s[40:43], s97 offen lds
    s_add_u32 m0, s77, 15360
    s_add_u32 s97, s74, 30720
    buffer_load_dwordx4 v14, s[40:43], s97 offen lds
    s_add_u32 m0, s77, 16384
    s_add_u32 s97, s74, 40960
    buffer_load_dwordx4 v13, s[40:43], s97 offen lds
    s_add_u32 m0, s77, 17408
    s_add_u32 s97, s74, 51200
    buffer_load_dwordx4 v14, s[40:43], s97 offen lds
    s_add_u32 m0, s77, 36864
    s_add_u32 s97, s74, 61440
    buffer_load_dwordx4 v13, s[40:43], s97 offen lds
    s_add_u32 m0, s77, 37888
    s_add_u32 s97, s74, 71680
    buffer_load_dwordx4 v14, s[40:43], s97 offen lds
    s_add_u32 m0, s77, 38912
    s_add_u32 s97, s74, 81920
    buffer_load_dwordx4 v13, s[40:43], s97 offen lds
    s_add_u32 m0, s77, 39936
    s_add_u32 s97, s74, 92160
    buffer_load_dwordx4 v14, s[40:43], s97 offen lds
    s_add_u32 m0, s77, 40960
    s_add_u32 s97, s74, 102400
    buffer_load_dwordx4 v13, s[40:43], s97 offen lds
    s_add_u32 m0, s77, 41984
    s_add_u32 s97, s74, 112640
    buffer_load_dwordx4 v14, s[40:43], s97 offen lds
    s_waitcnt vmcnt(20)
    s_barrier
    s_add_u32 s72, s72, 1
    s_cmp_ge_u32 s72, 10
    s_cselect_b32 s10, 10, 0
    s_sub_u32 s72, s72, s10
    s_lshl_b32 s73, s72, 19
    s_add_u32 s73, s73, s24
    s_lshl_b32 s74, s72, 7
    s_add_u32 s74, s74, s26
    s_add_u32 m0, s25, 49152
    s_add_u32 s97, s73, 0
    buffer_load_dwordx4 v11, s[52:55], s97 offen lds
    s_add_u32 m0, s25, 50176
    s_add_u32 s97, s73, 32768
    buffer_load_dwordx4 v11, s[52:55], s97 offen lds
    s_add_u32 m0, s25, 51200
    s_add_u32 s97, s73, 65536
    buffer_load_dwordx4 v12, s[52:55], s97 offen lds
    s_add_u32 m0, s25, 52224
    s_add_u32 s97, s73, 98304
    buffer_load_dwordx4 v12, s[52:55], s97 offen lds
    s_add_u32 m0, s25, 53248
    s_add_u32 s97, s73, 131072
    buffer_load_dwordx4 v11, s[52:55], s97 offen lds
    s_add_u32 m0, s25, 54272
    s_add_u32 s97, s73, 163840
    buffer_load_dwordx4 v11, s[52:55], s97 offen lds
    s_add_u32 m0, s25, 55296
    s_add_u32 s97, s73, 196608
    buffer_load_dwordx4 v12, s[52:55], s97 offen lds
    s_add_u32 m0, s25, 56320
    s_add_u32 s97, s73, 229376
    buffer_load_dwordx4 v12, s[52:55], s97 offen lds
    s_add_u32 m0, s77, 18432
    s_add_u32 s97, s74, 0
    buffer_load_dwordx4 v13, s[40:43], s97 offen lds
    s_add_u32 m0, s77, 19456
    s_add_u32 s97, s74, 10240
    buffer_load_dwordx4 v14, s[40:43], s97 offen lds
    s_add_u32 m0, s77, 20480
    s_add_u32 s97, s74, 20480
    buffer_load_dwordx4 v13, s[40:43], s97 offen lds
    s_add_u32 m0, s77, 21504
    s_add_u32 s97, s74, 30720
    buffer_load_dwordx4 v14, s[40:43], s97 offen lds
    s_add_u32 m0, s77, 22528
    s_add_u32 s97, s74, 40960
    buffer_load_dwordx4 v13, s[40:43], s97 offen lds
    s_add_u32 m0, s77, 23552
    s_add_u32 s97, s74, 51200
    buffer_load_dwordx4 v14, s[40:43], s97 offen lds
    s_add_u32 m0, s77, 43008
    s_add_u32 s97, s74, 61440
    buffer_load_dwordx4 v13, s[40:43], s97 offen lds
    s_add_u32 m0, s77, 44032
    s_add_u32 s97, s74, 71680
    buffer_load_dwordx4 v14, s[40:43], s97 offen lds
    s_add_u32 m0, s77, 45056
    s_add_u32 s97, s74, 81920
    buffer_load_dwordx4 v13, s[40:43], s97 offen lds
    s_add_u32 m0, s77, 46080
    s_add_u32 s97, s74, 92160
    buffer_load_dwordx4 v14, s[40:43], s97 offen lds
    s_add_u32 m0, s77, 47104
    s_add_u32 s97, s74, 102400
    buffer_load_dwordx4 v13, s[40:43], s97 offen lds
    s_add_u32 m0, s77, 48128
    s_add_u32 s97, s74, 112640
    buffer_load_dwordx4 v14, s[40:43], s97 offen lds
    s_waitcnt vmcnt(20)
    s_barrier
    s_add_u32 s72, s72, 1
    s_cmp_ge_u32 s72, 10
    s_cselect_b32 s10, 10, 0
    s_sub_u32 s72, s72, s10
    s_lshl_b32 s73, s72, 19
    s_add_u32 s73, s73, s24
    s_lshl_b32 s74, s72, 7
    s_add_u32 s74, s74, s26
    s_add_u32 m0, s25, 0
    s_add_u32 s97, s73, 0
    buffer_load_dwordx4 v11, s[52:55], s97 offen lds
    s_add_u32 m0, s25, 1024
    s_add_u32 s97, s73, 32768
    buffer_load_dwordx4 v11, s[52:55], s97 offen lds
    s_add_u32 m0, s25, 2048
    s_add_u32 s97, s73, 65536
    buffer_load_dwordx4 v12, s[52:55], s97 offen lds
    s_add_u32 m0, s25, 3072
    s_add_u32 s97, s73, 98304
    buffer_load_dwordx4 v12, s[52:55], s97 offen lds
    s_add_u32 m0, s25, 4096
    s_add_u32 s97, s73, 131072
    buffer_load_dwordx4 v11, s[52:55], s97 offen lds
    s_add_u32 m0, s25, 5120
    s_add_u32 s97, s73, 163840
    buffer_load_dwordx4 v11, s[52:55], s97 offen lds
    s_add_u32 m0, s25, 6144
    s_add_u32 s97, s73, 196608
    buffer_load_dwordx4 v12, s[52:55], s97 offen lds
    s_add_u32 m0, s25, 7168
    s_add_u32 s97, s73, 229376
    buffer_load_dwordx4 v12, s[52:55], s97 offen lds
    s_add_u32 m0, s77, 0
    s_add_u32 s97, s74, 0
    buffer_load_dwordx4 v13, s[40:43], s97 offen lds
    s_add_u32 m0, s77, 1024
    s_add_u32 s97, s74, 10240
    buffer_load_dwordx4 v14, s[40:43], s97 offen lds
    s_add_u32 m0, s77, 2048
    s_add_u32 s97, s74, 20480
    buffer_load_dwordx4 v13, s[40:43], s97 offen lds
    s_add_u32 m0, s77, 3072
    s_add_u32 s97, s74, 30720
    buffer_load_dwordx4 v14, s[40:43], s97 offen lds
    s_add_u32 m0, s77, 4096
    s_add_u32 s97, s74, 40960
    buffer_load_dwordx4 v13, s[40:43], s97 offen lds
    s_add_u32 m0, s77, 5120
    s_add_u32 s97, s74, 51200
    buffer_load_dwordx4 v14, s[40:43], s97 offen lds
    s_add_u32 m0, s77, 24576
    s_add_u32 s97, s74, 61440
    buffer_load_dwordx4 v13, s[40:43], s97 offen lds
    s_add_u32 m0, s77, 25600
    s_add_u32 s97, s74, 71680
    buffer_load_dwordx4 v14, s[40:43], s97 offen lds
    s_add_u32 m0, s77, 26624
    s_add_u32 s97, s74, 81920
    buffer_load_dwordx4 v13, s[40:43], s97 offen lds
    s_add_u32 m0, s77, 27648
    s_add_u32 s97, s74, 92160
    buffer_load_dwordx4 v14, s[40:43], s97 offen lds
    s_add_u32 m0, s77, 28672
    s_add_u32 s97, s74, 102400
    buffer_load_dwordx4 v13, s[40:43], s97 offen lds
    s_add_u32 m0, s77, 29696
    s_add_u32 s97, s74, 112640
    buffer_load_dwordx4 v14, s[40:43], s97 offen lds
    s_waitcnt vmcnt(20)
    s_barrier
    s_add_u32 s72, s72, 1
    s_cmp_ge_u32 s72, 10
    s_cselect_b32 s10, 10, 0
    s_sub_u32 s72, s72, s10
    s_lshl_b32 s73, s72, 19
    s_add_u32 s73, s73, s24
    s_lshl_b32 s74, s72, 7
    s_add_u32 s74, s74, s26
    s_add_u32 m0, s25, 16384
    s_add_u32 s97, s73, 0
    buffer_load_dwordx4 v11, s[52:55], s97 offen lds
    s_add_u32 m0, s25, 17408
    s_add_u32 s97, s73, 32768
    buffer_load_dwordx4 v11, s[52:55], s97 offen lds
    s_add_u32 m0, s25, 18432
    s_add_u32 s97, s73, 65536
    buffer_load_dwordx4 v12, s[52:55], s97 offen lds
    s_add_u32 m0, s25, 19456
    s_add_u32 s97, s73, 98304
    buffer_load_dwordx4 v12, s[52:55], s97 offen lds
    s_add_u32 m0, s25, 20480
    s_add_u32 s97, s73, 131072
    buffer_load_dwordx4 v11, s[52:55], s97 offen lds
    s_add_u32 m0, s25, 21504
    s_add_u32 s97, s73, 163840
    buffer_load_dwordx4 v11, s[52:55], s97 offen lds
    s_add_u32 m0, s25, 22528
    s_add_u32 s97, s73, 196608
    buffer_load_dwordx4 v12, s[52:55], s97 offen lds
    s_add_u32 m0, s25, 23552
    s_add_u32 s97, s73, 229376
    buffer_load_dwordx4 v12, s[52:55], s97 offen lds
    s_add_u32 m0, s77, 6144
    s_add_u32 s97, s74, 0
    buffer_load_dwordx4 v13, s[40:43], s97 offen lds
    s_add_u32 m0, s77, 7168
    s_add_u32 s97, s74, 10240
    buffer_load_dwordx4 v14, s[40:43], s97 offen lds
    s_add_u32 m0, s77, 8192
    s_add_u32 s97, s74, 20480
    buffer_load_dwordx4 v13, s[40:43], s97 offen lds
    s_add_u32 m0, s77, 9216
    s_add_u32 s97, s74, 30720
    buffer_load_dwordx4 v14, s[40:43], s97 offen lds
    s_add_u32 m0, s77, 10240
    s_add_u32 s97, s74, 40960
    buffer_load_dwordx4 v13, s[40:43], s97 offen lds
    s_add_u32 m0, s77, 11264
    s_add_u32 s97, s74, 51200
    buffer_load_dwordx4 v14, s[40:43], s97 offen lds
    s_add_u32 m0, s77, 30720
    s_add_u32 s97, s74, 61440
    buffer_load_dwordx4 v13, s[40:43], s97 offen lds
    s_add_u32 m0, s77, 31744
    s_add_u32 s97, s74, 71680
    buffer_load_dwordx4 v14, s[40:43], s97 offen lds
    s_add_u32 m0, s77, 32768
    s_add_u32 s97, s74, 81920
    buffer_load_dwordx4 v13, s[40:43], s97 offen lds
    s_add_u32 m0, s77, 33792
    s_add_u32 s97, s74, 92160
    buffer_load_dwordx4 v14, s[40:43], s97 offen lds
    s_add_u32 m0, s77, 34816
    s_add_u32 s97, s74, 102400
    buffer_load_dwordx4 v13, s[40:43], s97 offen lds
    s_add_u32 m0, s77, 35840
    s_add_u32 s97, s74, 112640
    buffer_load_dwordx4 v14, s[40:43], s97 offen lds
    s_waitcnt vmcnt(20)
    s_barrier
    s_lshl_b32 s10, s5, 1
    s_add_u32 s10, s10, s23
    s_mul_i32 s10, s10, 20480
    s_mul_i32 s11, s7, 1310720
    s_add_u32 s75, s10, s11
    v_lshlrev_b32 v16, 7, v1
    v_add_u32 v17, 0, v16
    buffer_load_dword v20, v17, s[60:63], s75 offen
    v_add_u32 v17, 8192, v16
    buffer_load_dword v21, v17, s[60:63], s75 offen
    v_add_u32 v17, 16384, v16
    v_cmp_lt_u32 vcc, 31, v1
    s_nop 1
    v_cndmask_b32 v17, v17, -1, vcc
    buffer_load_dword v22, v17, s[60:63], s75 offen
    s_waitcnt vmcnt(3)
    s_barrier
    s_barrier
    s_endpgm
L_kv:
    s_and_b32 s23, s79, 1
    v_lshlrev_b32 v7, 1, v2
    v_xor_b32 v7, v7, v3
    v_lshlrev_b32 v7, 4, v7
    v_lshl_add_u32 v11, v2, 8, v7
    v_xor_b32 v12, 0x80, v11
    s_mul_i32 s77, s23, 49152
    s_add_u32 s77, s77, 65536
    v_add_u32 v13, s77, v10
    v_xor_b32 v7, v2, v3
    v_lshlrev_b32 v7, 4, v7
    v_lshl_add_u32 v14, v2, 8, v7
    v_xor_b32 v15, 0x40, v14
    v_xor_b32 v16, 0x80, v14
    v_xor_b32 v17, 0xc0, v14
    s_lshl_b32 s22, s9, 2
    s_lshl_b32 s10, s23, 1
    s_add_u32 s22, s22, s10
    s_lshl_b32 s10, s22, 5
    s_add_u32 s10, s10, s16
    s_mul_i32 s24, s10, 12288
    s_add_u32 s25, s24, 4096
    s_add_u32 s26, s24, 8192
    s_add_u32 s27, s24, 393216
    s_add_u32 s28, s27, 4096
    s_add_u32 s29, s27, 8192
    s_barrier
    s_barrier
    s_barrier
    buffer_load_dwordx4 v[32:35], v14, s[44:47], s24 offen offset:0 nt
    buffer_load_dwordx4 v[36:39], v15, s[44:47], s24 offen offset:1024 nt
    buffer_load_dwordx4 v[40:43], v16, s[44:47], s24 offen offset:2048 nt
    buffer_load_dwordx4 v[44:47], v17, s[44:47], s24 offen offset:3072 nt
    buffer_load_dwordx4 v[48:51], v14, s[44:47], s25 offen offset:0 nt
    buffer_load_dwordx4 v[52:55], v15, s[44:47], s25 offen offset:1024 nt
    buffer_load_dwordx4 v[56:59], v16, s[44:47], s25 offen offset:2048 nt
    s_barrier
    buffer_load_dwordx4 v[60:63], v17, s[44:47], s25 offen offset:3072 nt
    buffer_load_dwordx4 v[64:67], v14, s[44:47], s26 offen offset:0 nt
    buffer_load_dwordx4 v[68:71], v15, s[44:47], s26 offen offset:1024 nt
    buffer_load_dwordx4 v[72:75], v16, s[44:47], s26 offen offset:2048 nt
    buffer_load_dwordx4 v[76:79], v17, s[44:47], s26 offen offset:3072 nt
    buffer_load_dwordx4 v[128:131], v14, s[44:47], s27 offen offset:0 nt
    buffer_load_dwordx4 v[132:135], v15, s[44:47], s27 offen offset:1024 nt
    s_barrier
    buffer_load_dwordx4 v[136:139], v16, s[44:47], s27 offen offset:2048 nt
    buffer_load_dwordx4 v[140:143], v17, s[44:47], s27 offen offset:3072 nt
    buffer_load_dwordx4 v[144:147], v14, s[44:47], s28 offen offset:0 nt
    buffer_load_dwordx4 v[148:151], v15, s[44:47], s28 offen offset:1024 nt
    buffer_load_dwordx4 v[152:155], v16, s[44:47], s28 offen offset:2048 nt
    buffer_load_dwordx4 v[156:159], v17, s[44:47], s28 offen offset:3072 nt
    buffer_load_dwordx4 v[160:163], v14, s[44:47], s29 offen offset:0 nt
    s_barrier
    buffer_load_dwordx4 v[164:167], v15, s[44:47], s29 offen offset:1024 nt
    buffer_load_dwordx4 v[168:171], v16, s[44:47], s29 offen offset:2048 nt
    buffer_load_dwordx4 v[172:175], v17, s[44:47], s29 offen offset:3072 nt
    buffer_load_dwordx4 v[80:83], v11, s[48:51], s24 offen offset:0 nt
    buffer_load_dwordx4 v[84:87], v12, s[48:51], s24 offen offset:1024 nt
    buffer_load_dwordx4 v[88:91], v11, s[48:51], s24 offen offset:2048 nt
    buffer_load_dwordx4 v[92:95], v12, s[48:51], s24 offen offset:3072 nt
    s_barrier
    buffer_load_dwordx4 v[96:99], v11, s[48:51], s25 offen offset:0 nt
    buffer_load_dwordx4 v[100:103], v12, s[48:51], s25 offen offset:1024 nt
    buffer_load_dwordx4 v[104:107], v11, s[48:51], s25 offen offset:2048 nt
    buffer_load_dwordx4 v[108:111], v12, s[48:51], s25 offen offset:3072 nt
    buffer_load_dwordx4 v[112:115], v11, s[48:51], s26 offen offset:0 nt
    buffer_load_dwordx4 v[116:119], v12, s[48:51], s26 offen offset:1024 nt
    buffer_load_dwordx4 v[120:123], v11, s[48:51], s26 offen offset:2048 nt
    s_barrier
    buffer_load_dwordx4 v[124:127], v12, s[48:51], s26 offen offset:3072 nt
    buffer_load_dwordx4 v[176:179], v11, s[48:51], s27 offen offset:0 nt
    buffer_load_dwordx4 v[180:183], v12, s[48:51], s27 offen offset:1024 nt
    buffer_load_dwordx4 v[184:187], v11, s[48:51], s27 offen offset:2048 nt
    buffer_load_dwordx4 v[188:191], v12, s[48:51], s27 offen offset:3072 nt
    buffer_load_dwordx4 v[192:195], v11, s[48:51], s28 offen offset:0 nt
    buffer_load_dwordx4 v[196:199], v12, s[48:51], s28 offen offset:1024 nt
    s_barrier
    buffer_load_dwordx4 v[200:203], v11, s[48:51], s28 offen offset:2048 nt
    buffer_load_dwordx4 v[204:207], v12, s[48:51], s28 offen offset:3072 nt
    buffer_load_dwordx4 v[208:211], v11, s[48:51], s29 offen offset:0 nt
    buffer_load_dwordx4 v[212:215], v12, s[48:51], s29 offen offset:1024 nt
    buffer_load_dwordx4 v[216:219], v11, s[48:51], s29 offen offset:2048 nt
    buffer_load_dwordx4 v[220:223], v12, s[48:51], s29 offen offset:3072 nt
    s_barrier
    s_barrier
    s_waitcnt vmcnt(47)
    ds_write_b128 v13, v[32:35] offset:12288
    s_waitcnt vmcnt(46)
    ds_write_b128 v13, v[36:39] offset:13312
    s_waitcnt vmcnt(45)
    ds_write_b128 v13, v[40:43] offset:14336
    s_waitcnt vmcnt(44)
    ds_write_b128 v13, v[44:47] offset:15360
    s_waitcnt vmcnt(43)
    ds_write_b128 v13, v[48:51] offset:16384
    s_waitcnt vmcnt(42)
    ds_write_b128 v13, v[52:55] offset:17408
    s_waitcnt vmcnt(41)
    ds_write_b128 v13, v[56:59] offset:18432
    s_waitcnt vmcnt(40)
    ds_write_b128 v13, v[60:63] offset:19456
    s_waitcnt vmcnt(39)
    ds_write_b128 v13, v[64:67] offset:20480
    s_waitcnt vmcnt(38)
    ds_write_b128 v13, v[68:71] offset:21504
    s_waitcnt vmcnt(37)
    ds_write_b128 v13, v[72:75] offset:22528
    s_waitcnt vmcnt(36)
    ds_write_b128 v13, v[76:79] offset:23552
    s_waitcnt vmcnt(35)
    ds_write_b128 v13, v[128:131] offset:36864
    s_waitcnt vmcnt(34)
    ds_write_b128 v13, v[132:135] offset:37888
    s_waitcnt vmcnt(33)
    ds_write_b128 v13, v[136:139] offset:38912
    s_waitcnt vmcnt(32)
    ds_write_b128 v13, v[140:143] offset:39936
    s_waitcnt vmcnt(31)
    ds_write_b128 v13, v[144:147] offset:40960
    s_waitcnt vmcnt(30)
    ds_write_b128 v13, v[148:151] offset:41984
    s_waitcnt vmcnt(29)
    ds_write_b128 v13, v[152:155] offset:43008
    s_waitcnt vmcnt(28)
    ds_write_b128 v13, v[156:159] offset:44032
    s_waitcnt vmcnt(27)
    ds_write_b128 v13, v[160:163] offset:45056
    s_waitcnt vmcnt(26)
    ds_write_b128 v13, v[164:167] offset:46080
    s_waitcnt vmcnt(25)
    ds_write_b128 v13, v[168:171] offset:47104
    s_waitcnt vmcnt(24)
    ds_write_b128 v13, v[172:175] offset:48128
    s_waitcnt lgkmcnt(0)
    s_barrier
    s_waitcnt vmcnt(23)
    ds_write_b128 v13, v[80:83] offset:0
    s_waitcnt vmcnt(22)
    ds_write_b128 v13, v[84:87] offset:1024
    s_waitcnt vmcnt(21)
    ds_write_b128 v13, v[88:91] offset:2048
    s_waitcnt vmcnt(20)
    ds_write_b128 v13, v[92:95] offset:3072
    s_waitcnt vmcnt(19)
    ds_write_b128 v13, v[96:99] offset:4096
    s_waitcnt vmcnt(18)
    ds_write_b128 v13, v[100:103] offset:5120
    s_waitcnt vmcnt(17)
    ds_write_b128 v13, v[104:107] offset:6144
    s_waitcnt vmcnt(16)
    ds_write_b128 v13, v[108:111] offset:7168
    s_waitcnt vmcnt(15)
    ds_write_b128 v13, v[112:115] offset:8192
    s_waitcnt vmcnt(14)
    ds_write_b128 v13, v[116:119] offset:9216
    s_waitcnt vmcnt(13)
    ds_write_b128 v13, v[120:123] offset:10240
    s_waitcnt vmcnt(12)
    ds_write_b128 v13, v[124:127] offset:11264
    s_waitcnt vmcnt(11)
    ds_write_b128 v13, v[176:179] offset:24576
    s_waitcnt vmcnt(10)
    ds_write_b128 v13, v[180:183] offset:25600
    s_waitcnt vmcnt(9)
    ds_write_b128 v13, v[184:187] offset:26624
    s_waitcnt vmcnt(8)
    ds_write_b128 v13, v[188:191] offset:27648
    s_waitcnt vmcnt(7)
    ds_write_b128 v13, v[192:195] offset:28672
    s_waitcnt vmcnt(6)
    ds_write_b128 v13, v[196:199] offset:29696
    s_waitcnt vmcnt(5)
    ds_write_b128 v13, v[200:203] offset:30720
    s_waitcnt vmcnt(4)
    ds_write_b128 v13, v[204:207] offset:31744
    s_waitcnt vmcnt(3)
    ds_write_b128 v13, v[208:211] offset:32768
    s_waitcnt vmcnt(2)
    ds_write_b128 v13, v[212:215] offset:33792
    s_waitcnt vmcnt(1)
    ds_write_b128 v13, v[216:219] offset:34816
    s_waitcnt vmcnt(0)
    ds_write_b128 v13, v[220:223] offset:35840
    s_waitcnt lgkmcnt(0)
    s_barrier
L_end_k1:
    s_endpgm
.globl k2_kernel
.p2align 8
.type k2_kernel,@function
k2_kernel:
    s_cmp_ge_u32 s2, 240
    s_cbranch_scc1 L_end_k2
    s_load_dwordx2 s[24:25], s[0:1], 32
    s_load_dwordx2 s[34:35], s[0:1], 72
    s_load_dwordx2 s[36:37], s[0:1], 80
    s_load_dwordx2 s[14:15], s[0:1], 96
    v_and_b32 v1, 63, v0
    v_lshrrev_b32 v7, 6, v0
    v_lshrrev_b32 v2, 4, v1
    v_readfirstlane_b32 s79, v7
    v_and_b32 v3, 15, v0
    v_lshlrev_b32 v10, 4, v1
    s_and_b32 s4, s2, 7
    s_lshr_b32 s5, s2, 3
    s_lshr_b32 s6, s4, 2
    s_and_b32 s7, s4, 3
    s_mul_i32 s17, s5, 13
    s_lshr_b32 s17, s17, 6
    s_mul_i32 s10, s17, 5
    s_sub_u32 s18, s5, s10
    s_and_b32 s3, s79, 3
    s_waitcnt lgkmcnt(0)
    s_cmp_eq_u32 s6, 0
    s_cselect_b32 s60, s24, s34
    s_cselect_b32 s61, s25, s35
    s_mov_b32 s62, 5242880
    s_mov_b32 s63, 0x20000
    s_mov_b32 s56, s14
    s_mov_b32 s57, s15
    s_mov_b32 s58, 268435456
    s_mov_b32 s59, 0x20000
    s_mov_b32 s64, s36
    s_mov_b32 s65, s37
    s_mov_b32 s66, 1966080
    s_mov_b32 s67, 0x20000
    s_cmp_ge_u32 s79, 4
    s_cbranch_scc1 L_loader_k2
    v_bfe_u32 v4, v0, 2, 2
    v_and_b32 v5, 3, v0
    s_lshr_b32 s10, s3, 1
    s_and_b32 s11, s3, 1
    v_and_b32 v7, 1, v2
    v_lshlrev_b32 v7, 2, v7
    v_or_b32 v6, v4, v7
    v_lshl_add_u32 v7, v2, 2, v4
    v_lshlrev_b32 v7, 8, v7
    v_lshl_add_u32 v7, v5, 3, v7
    s_lshl_b32 s13, s11, 2
    s_add_u32 s12, s13, 0
    v_xor_b32 v9, s12, v6
    v_lshl_add_u32 v11, v9, 5, v7
    v_add_u32 v15, 0x10000, v11
    v_add_u32 v19, 0x20000, v11
    s_add_u32 s12, s13, 1
    v_xor_b32 v9, s12, v6
    v_lshl_add_u32 v12, v9, 5, v7
    v_add_u32 v16, 0x10000, v12
    v_add_u32 v20, 0x20000, v12
    s_add_u32 s12, s13, 2
    v_xor_b32 v9, s12, v6
    v_lshl_add_u32 v13, v9, 5, v7
    v_add_u32 v17, 0x10000, v13
    v_add_u32 v21, 0x20000, v13
    s_add_u32 s12, s13, 3
    v_xor_b32 v9, s12, v6
    v_lshl_add_u32 v14, v9, 5, v7
    v_add_u32 v18, 0x10000, v14
    v_add_u32 v22, 0x20000, v14
    s_lshl_b32 s13, s10, 13
    v_add_u32 v23, s13, v10
    v_add_u32 v24, 0x10000, v23
    v_add_u32 v25, 0x20000, v23
    v_mul_u32_u24 v26, 2560, v3
    v_lshl_add_u32 v26, v2, 3, v26
    s_mul_i32 s13, s6, 30
    s_add_u32 s13, s13, s5
    s_lshl_b32 s13, s13, 4
    s_add_u32 s13, s13, s3
    s_lshl_b32 s27, s13, 14
    s_add_u32 s27, s27, 16777216
    s_lshl_b32 s12, s7, 16
    s_add_u32 s28, s27, s12
    s_lshl_b32 s13, s17, 7
    s_lshl_b32 s12, s10, 6
    s_add_u32 s13, s13, s12
    s_mul_i32 s29, s13, 2560
    s_mul_i32 s13, s6, 1280
    s_add_u32 s29, s29, s13
    s_lshl_b32 s13, s18, 8
    s_add_u32 s29, s29, s13
    s_lshl_b32 s13, s11, 7
    s_add_u32 s29, s29, s13
    s_lshl_b32 s13, s7, 5
    s_add_u32 s29, s29, s13
    s_barrier
    ds_read_b128 v[48:51], v23 offset:0
    ds_read_b128 v[52:55], v23 offset:2048
    ds_read_b128 v[56:59], v23 offset:4096
    ds_read_b128 v[60:63], v23 offset:6144
    ds_read_b64_tr_b16 v[32:33], v11 offset:16384
    ds_read_b64_tr_b16 v[34:35], v11 offset:20480
    ds_read_b64_tr_b16 v[36:37], v12 offset:16384
    ds_read_b64_tr_b16 v[38:39], v12 offset:20480
    ds_read_b64_tr_b16 v[40:41], v13 offset:16384
    ds_read_b64_tr_b16 v[42:43], v13 offset:20480
    ds_read_b64_tr_b16 v[44:45], v14 offset:16384
    ds_read_b64_tr_b16 v[46:47], v14 offset:20480
    s_waitcnt lgkmcnt(6)
    v_mfma_f32_16x16x32_bf16 v[96:99], v[32:35], v[48:51], 0
    ds_read_b128 v[80:83], v23 offset:1024
    v_mfma_f32_16x16x32_bf16 v[100:103], v[32:35], v[52:55], 0
    ds_read_b128 v[84:87], v23 offset:3072
    v_mfma_f32_16x16x32_bf16 v[104:107], v[32:35], v[56:59], 0
    ds_read_b128 v[88:91], v23 offset:5120
    v_mfma_f32_16x16x32_bf16 v[108:111], v[32:35], v[60:63], 0
    ds_read_b128 v[92:95], v23 offset:7168
    s_waitcnt lgkmcnt(8)
    v_mfma_f32_16x16x32_bf16 v[112:115], v[36:39], v[48:51], 0
    ds_read_b64_tr_b16 v[64:65], v11 offset:24576
    v_mfma_f32_16x16x32_bf16 v[116:119], v[36:39], v[52:55], 0
    ds_read_b64_tr_b16 v[66:67], v11 offset:28672
    v_mfma_f32_16x16x32_bf16 v[120:123], v[36:39], v[56:59], 0
    ds_read_b64_tr_b16 v[68:69], v12 offset:24576
    v_mfma_f32_16x16x32_bf16 v[124:127], v[36:39], v[60:63], 0
    ds_read_b64_tr_b16 v[70:71], v12 offset:28672
    s_waitcnt lgkmcnt(10)
    v_mfma_f32_16x16x32_bf16 v[128:131], v[40:43], v[48:51], 0
    ds_read_b64_tr_b16 v[72:73], v13 offset:24576
    v_mfma_f32_16x16x32_bf16 v[132:135], v[40:43], v[52:55], 0
    ds_read_b64_tr_b16 v[74:75], v13 offset:28672
    v_mfma_f32_16x16x32_bf16 v[136:139], v[40:43], v[56:59], 0
    ds_read_b64_tr_b16 v[76:77], v14 offset:24576
    v_mfma_f32_16x16x32_bf16 v[140:143], v[40:43], v[60:63], 0
    ds_read_b64_tr_b16 v[78:79], v14 offset:28672
    s_waitcnt lgkmcnt(12)
    v_mfma_f32_16x16x32_bf16 v[144:147], v[44:47], v[48:51], 0
    v_mfma_f32_16x16x32_bf16 v[148:151], v[44:47], v[52:55], 0
    v_mfma_f32_16x16x32_bf16 v[152:155], v[44:47], v[56:59], 0
    v_mfma_f32_16x16x32_bf16 v[156:159], v[44:47], v[60:63], 0
    s_barrier
    s_waitcnt lgkmcnt(6)
    v_mfma_f32_16x16x32_bf16 v[96:99], v[64:67], v[80:83], v[96:99]
    ds_read_b128 v[48:51], v23 offset:32768
    v_mfma_f32_16x16x32_bf16 v[100:103], v[64:67], v[84:87], v[100:103]
    ds_read_b128 v[52:55], v23 offset:34816
    v_mfma_f32_16x16x32_bf16 v[104:107], v[64:67], v[88:91], v[104:107]
    ds_read_b128 v[56:59], v23 offset:36864
    v_mfma_f32_16x16x32_bf16 v[108:111], v[64:67], v[92:95], v[108:111]
    ds_read_b128 v[60:63], v23 offset:38912
    s_waitcnt lgkmcnt(8)
    v_mfma_f32_16x16x32_bf16 v[112:115], v[68:71], v[80:83], v[112:115]
    ds_read_b64_tr_b16 v[32:33], v11 offset:49152
    v_mfma_f32_16x16x32_bf16 v[116:119], v[68:71], v[84:87], v[116:119]
    ds_read_b64_tr_b16 v[34:35], v11 offset:53248
    v_mfma_f32_16x16x32_bf16 v[120:123], v[68:71], v[88:91], v[120:123]
    ds_read_b64_tr_b16 v[36:37], v12 offset:49152
    v_mfma_f32_16x16x32_bf16 v[124:127], v[68:71], v[92:95], v[124:127]
    ds_read_b64_tr_b16 v[38:39], v12 offset:53248
    s_waitcnt lgkmcnt(10)
    v_mfma_f32_16x16x32_bf16 v[128:131], v[72:75], v[80:83], v[128:131]
    ds_read_b64_tr_b16 v[40:41], v13 offset:49152
    v_mfma_f32_16x16x32_bf16 v[132:135], v[72:75], v[84:87], v[132:135]
    ds_read_b64_tr_b16 v[42:43], v13 offset:53248
    v_mfma_f32_16x16x32_bf16 v[136:139], v[72:75], v[88:91], v[136:139]
    ds_read_b64_tr_b16 v[44:45], v14 offset:49152
    v_mfma_f32_16x16x32_bf16 v[140:143], v[72:75], v[92:95], v[140:143]
    ds_read_b64_tr_b16 v[46:47], v14 offset:53248
    s_waitcnt lgkmcnt(12)
    v_mfma_f32_16x16x32_bf16 v[144:147], v[76:79], v[80:83], v[144:147]
    v_mfma_f32_16x16x32_bf16 v[148:151], v[76:79], v[84:87], v[148:151]
    v_mfma_f32_16x16x32_bf16 v[152:155], v[76:79], v[88:91], v[152:155]
    v_mfma_f32_16x16x32_bf16 v[156:159], v[76:79], v[92:95], v[156:159]
    s_waitcnt lgkmcnt(6)
    v_mfma_f32_16x16x32_bf16 v[96:99], v[32:35], v[48:51], v[96:99]
    ds_read_b128 v[80:83], v23 offset:33792
    v_mfma_f32_16x16x32_bf16 v[100:103], v[32:35], v[52:55], v[100:103]
    ds_read_b128 v[84:87], v23 offset:35840
    v_mfma_f32_16x16x32_bf16 v[104:107], v[32:35], v[56:59], v[104:107]
    ds_read_b128 v[88:91], v23 offset:37888
    v_mfma_f32_16x16x32_bf16 v[108:111], v[32:35], v[60:63], v[108:111]
    ds_read_b128 v[92:95], v23 offset:39936
    s_waitcnt lgkmcnt(8)
    v_mfma_f32_16x16x32_bf16 v[112:115], v[36:39], v[48:51], v[112:115]
    ds_read_b64_tr_b16 v[64:65], v11 offset:57344
    v_mfma_f32_16x16x32_bf16 v[116:119], v[36:39], v[52:55], v[116:119]
    ds_read_b64_tr_b16 v[66:67], v11 offset:61440
    v_mfma_f32_16x16x32_bf16 v[120:123], v[36:39], v[56:59], v[120:123]
    ds_read_b64_tr_b16 v[68:69], v12 offset:57344
    v_mfma_f32_16x16x32_bf16 v[124:127], v[36:39], v[60:63], v[124:127]
    ds_read_b64_tr_b16 v[70:71], v12 offset:61440
    s_waitcnt lgkmcnt(10)
    v_mfma_f32_16x16x32_bf16 v[128:131], v[40:43], v[48:51], v[128:131]
    ds_read_b64_tr_b16 v[72:73], v13 offset:57344
    v_mfma_f32_16x16x32_bf16 v[132:135], v[40:43], v[52:55], v[132:135]
    ds_read_b64_tr_b16 v[74:75], v13 offset:61440
    v_mfma_f32_16x16x32_bf16 v[136:139], v[40:43], v[56:59], v[136:139]
    ds_read_b64_tr_b16 v[76:77], v14 offset:57344
    v_mfma_f32_16x16x32_bf16 v[140:143], v[40:43], v[60:63], v[140:143]
    ds_read_b64_tr_b16 v[78:79], v14 offset:61440
    s_waitcnt lgkmcnt(12)
    v_mfma_f32_16x16x32_bf16 v[144:147], v[44:47], v[48:51], v[144:147]
    v_mfma_f32_16x16x32_bf16 v[148:151], v[44:47], v[52:55], v[148:151]
    v_mfma_f32_16x16x32_bf16 v[152:155], v[44:47], v[56:59], v[152:155]
    v_mfma_f32_16x16x32_bf16 v[156:159], v[44:47], v[60:63], v[156:159]
    s_barrier
    s_waitcnt lgkmcnt(6)
    v_mfma_f32_16x16x32_bf16 v[96:99], v[64:67], v[80:83], v[96:99]
    ds_read_b128 v[48:51], v24 offset:0
    v_mfma_f32_16x16x32_bf16 v[100:103], v[64:67], v[84:87], v[100:103]
    ds_read_b128 v[52:55], v24 offset:2048
    v_mfma_f32_16x16x32_bf16 v[104:107], v[64:67], v[88:91], v[104:107]
    ds_read_b128 v[56:59], v24 offset:4096
    v_mfma_f32_16x16x32_bf16 v[108:111], v[64:67], v[92:95], v[108:111]
    ds_read_b128 v[60:63], v24 offset:6144
    s_waitcnt lgkmcnt(8)
    v_mfma_f32_16x16x32_bf16 v[112:115], v[68:71], v[80:83], v[112:115]
    ds_read_b64_tr_b16 v[32:33], v15 offset:16384
    v_mfma_f32_16x16x32_bf16 v[116:119], v[68:71], v[84:87], v[116:119]
    ds_read_b64_tr_b16 v[34:35], v15 offset:20480
    v_mfma_f32_16x16x32_bf16 v[120:123], v[68:71], v[88:91], v[120:123]
    ds_read_b64_tr_b16 v[36:37], v16 offset:16384
    v_mfma_f32_16x16x32_bf16 v[124:127], v[68:71], v[92:95], v[124:127]
    ds_read_b64_tr_b16 v[38:39], v16 offset:20480
    s_waitcnt lgkmcnt(10)
    v_mfma_f32_16x16x32_bf16 v[128:131], v[72:75], v[80:83], v[128:131]
    ds_read_b64_tr_b16 v[40:41], v17 offset:16384
    v_mfma_f32_16x16x32_bf16 v[132:135], v[72:75], v[84:87], v[132:135]
    ds_read_b64_tr_b16 v[42:43], v17 offset:20480
    v_mfma_f32_16x16x32_bf16 v[136:139], v[72:75], v[88:91], v[136:139]
    ds_read_b64_tr_b16 v[44:45], v18 offset:16384
    v_mfma_f32_16x16x32_bf16 v[140:143], v[72:75], v[92:95], v[140:143]
    ds_read_b64_tr_b16 v[46:47], v18 offset:20480
    s_waitcnt lgkmcnt(12)
    v_mfma_f32_16x16x32_bf16 v[144:147], v[76:79], v[80:83], v[144:147]
    v_mfma_f32_16x16x32_bf16 v[148:151], v[76:79], v[84:87], v[148:151]
    v_mfma_f32_16x16x32_bf16 v[152:155], v[76:79], v[88:91], v[152:155]
    v_mfma_f32_16x16x32_bf16 v[156:159], v[76:79], v[92:95], v[156:159]
    s_waitcnt lgkmcnt(6)
    v_mfma_f32_16x16x32_bf16 v[96:99], v[32:35], v[48:51], v[96:99]
    ds_read_b128 v[80:83], v24 offset:1024
    v_mfma_f32_16x16x32_bf16 v[100:103], v[32:35], v[52:55], v[100:103]
    ds_read_b128 v[84:87], v24 offset:3072
    v_mfma_f32_16x16x32_bf16 v[104:107], v[32:35], v[56:59], v[104:107]
    ds_read_b128 v[88:91], v24 offset:5120
    v_mfma_f32_16x16x32_bf16 v[108:111], v[32:35], v[60:63], v[108:111]
    ds_read_b128 v[92:95], v24 offset:7168
    s_waitcnt lgkmcnt(8)
    v_mfma_f32_16x16x32_bf16 v[112:115], v[36:39], v[48:51], v[112:115]
    ds_read_b64_tr_b16 v[64:65], v15 offset:24576
    v_mfma_f32_16x16x32_bf16 v[116:119], v[36:39], v[52:55], v[116:119]
    ds_read_b64_tr_b16 v[66:67], v15 offset:28672
    v_mfma_f32_16x16x32_bf16 v[120:123], v[36:39], v[56:59], v[120:123]
    ds_read_b64_tr_b16 v[68:69], v16 offset:24576
    v_mfma_f32_16x16x32_bf16 v[124:127], v[36:39], v[60:63], v[124:127]
    ds_read_b64_tr_b16 v[70:71], v16 offset:28672
    s_waitcnt lgkmcnt(10)
    v_mfma_f32_16x16x32_bf16 v[128:131], v[40:43], v[48:51], v[128:131]
    ds_read_b64_tr_b16 v[72:73], v17 offset:24576
    v_mfma_f32_16x16x32_bf16 v[132:135], v[40:43], v[52:55], v[132:135]
    ds_read_b64_tr_b16 v[74:75], v17 offset:28672
    v_mfma_f32_16x16x32_bf16 v[136:139], v[40:43], v[56:59], v[136:139]
    ds_read_b64_tr_b16 v[76:77], v18 offset:24576
    v_mfma_f32_16x16x32_bf16 v[140:143], v[40:43], v[60:63], v[140:143]
    ds_read_b64_tr_b16 v[78:79], v18 offset:28672
    s_waitcnt lgkmcnt(12)
    v_mfma_f32_16x16x32_bf16 v[144:147], v[44:47], v[48:51], v[144:147]
    v_mfma_f32_16x16x32_bf16 v[148:151], v[44:47], v[52:55], v[148:151]
    v_mfma_f32_16x16x32_bf16 v[152:155], v[44:47], v[56:59], v[152:155]
    v_mfma_f32_16x16x32_bf16 v[156:159], v[44:47], v[60:63], v[156:159]
    s_barrier
    s_waitcnt lgkmcnt(6)
    v_mfma_f32_16x16x32_bf16 v[96:99], v[64:67], v[80:83], v[96:99]
    ds_read_b128 v[48:51], v24 offset:32768
    v_mfma_f32_16x16x32_bf16 v[100:103], v[64:67], v[84:87], v[100:103]
    ds_read_b128 v[52:55], v24 offset:34816
    v_mfma_f32_16x16x32_bf16 v[104:107], v[64:67], v[88:91], v[104:107]
    ds_read_b128 v[56:59], v24 offset:36864
    v_mfma_f32_16x16x32_bf16 v[108:111], v[64:67], v[92:95], v[108:111]
    ds_read_b128 v[60:63], v24 offset:38912
    s_waitcnt lgkmcnt(8)
    v_mfma_f32_16x16x32_bf16 v[112:115], v[68:71], v[80:83], v[112:115]
    ds_read_b64_tr_b16 v[32:33], v15 offset:49152
    v_mfma_f32_16x16x32_bf16 v[116:119], v[68:71], v[84:87], v[116:119]
    ds_read_b64_tr_b16 v[34:35], v15 offset:53248
    v_mfma_f32_16x16x32_bf16 v[120:123], v[68:71], v[88:91], v[120:123]
    ds_read_b64_tr_b16 v[36:37], v16 offset:49152
    v_mfma_f32_16x16x32_bf16 v[124:127], v[68:71], v[92:95], v[124:127]
    ds_read_b64_tr_b16 v[38:39], v16 offset:53248
    s_waitcnt lgkmcnt(10)
    v_mfma_f32_16x16x32_bf16 v[128:131], v[72:75], v[80:83], v[128:131]
    ds_read_b64_tr_b16 v[40:41], v17 offset:49152
    v_mfma_f32_16x16x32_bf16 v[132:135], v[72:75], v[84:87], v[132:135]
    ds_read_b64_tr_b16 v[42:43], v17 offset:53248
    v_mfma_f32_16x16x32_bf16 v[136:139], v[72:75], v[88:91], v[136:139]
    ds_read_b64_tr_b16 v[44:45], v18 offset:49152
    v_mfma_f32_16x16x32_bf16 v[140:143], v[72:75], v[92:95], v[140:143]
    ds_read_b64_tr_b16 v[46:47], v18 offset:53248
    s_waitcnt lgkmcnt(12)
    v_mfma_f32_16x16x32_bf16 v[144:147], v[76:79], v[80:83], v[144:147]
    v_mfma_f32_16x16x32_bf16 v[148:151], v[76:79], v[84:87], v[148:151]
    v_mfma_f32_16x16x32_bf16 v[152:155], v[76:79], v[88:91], v[152:155]
    v_mfma_f32_16x16x32_bf16 v[156:159], v[76:79], v[92:95], v[156:159]
    s_waitcnt lgkmcnt(6)
    v_mfma_f32_16x16x32_bf16 v[96:99], v[32:35], v[48:51], v[96:99]
    ds_read_b128 v[80:83], v24 offset:33792
    v_mfma_f32_16x16x32_bf16 v[100:103], v[32:35], v[52:55], v[100:103]
    ds_read_b128 v[84:87], v24 offset:35840
    v_mfma_f32_16x16x32_bf16 v[104:107], v[32:35], v[56:59], v[104:107]
    ds_read_b128 v[88:91], v24 offset:37888
    v_mfma_f32_16x16x32_bf16 v[108:111], v[32:35], v[60:63], v[108:111]
    ds_read_b128 v[92:95], v24 offset:39936
    s_waitcnt lgkmcnt(8)
    v_mfma_f32_16x16x32_bf16 v[112:115], v[36:39], v[48:51], v[112:115]
    ds_read_b64_tr_b16 v[64:65], v15 offset:57344
    v_mfma_f32_16x16x32_bf16 v[116:119], v[36:39], v[52:55], v[116:119]
    ds_read_b64_tr_b16 v[66:67], v15 offset:61440
    v_mfma_f32_16x16x32_bf16 v[120:123], v[36:39], v[56:59], v[120:123]
    ds_read_b64_tr_b16 v[68:69], v16 offset:57344
    v_mfma_f32_16x16x32_bf16 v[124:127], v[36:39], v[60:63], v[124:127]
    ds_read_b64_tr_b16 v[70:71], v16 offset:61440
    s_waitcnt lgkmcnt(10)
    v_mfma_f32_16x16x32_bf16 v[128:131], v[40:43], v[48:51], v[128:131]
    ds_read_b64_tr_b16 v[72:73], v17 offset:57344
    v_mfma_f32_16x16x32_bf16 v[132:135], v[40:43], v[52:55], v[132:135]
    ds_read_b64_tr_b16 v[74:75], v17 offset:61440
    v_mfma_f32_16x16x32_bf16 v[136:139], v[40:43], v[56:59], v[136:139]
    ds_read_b64_tr_b16 v[76:77], v18 offset:57344
    v_mfma_f32_16x16x32_bf16 v[140:143], v[40:43], v[60:63], v[140:143]
    ds_read_b64_tr_b16 v[78:79], v18 offset:61440
    s_waitcnt lgkmcnt(12)
    v_mfma_f32_16x16x32_bf16 v[144:147], v[44:47], v[48:51], v[144:147]
    v_mfma_f32_16x16x32_bf16 v[148:151], v[44:47], v[52:55], v[148:151]
    v_mfma_f32_16x16x32_bf16 v[152:155], v[44:47], v[56:59], v[152:155]
    v_mfma_f32_16x16x32_bf16 v[156:159], v[44:47], v[60:63], v[156:159]
    s_barrier
    s_waitcnt lgkmcnt(6)
    v_mfma_f32_16x16x32_bf16 v[96:99], v[64:67], v[80:83], v[96:99]
    ds_read_b128 v[48:51], v25 offset:0
    v_mfma_f32_16x16x32_bf16 v[100:103], v[64:67], v[84:87], v[100:103]
    ds_read_b128 v[52:55], v25 offset:2048
    v_mfma_f32_16x16x32_bf16 v[104:107], v[64:67], v[88:91], v[104:107]
    ds_read_b128 v[56:59], v25 offset:4096
    v_mfma_f32_16x16x32_bf16 v[108:111], v[64:67], v[92:95], v[108:111]
    ds_read_b128 v[60:63], v25 offset:6144
    s_waitcnt lgkmcnt(8)
    v_mfma_f32_16x16x32_bf16 v[112:115], v[68:71], v[80:83], v[112:115]
    ds_read_b64_tr_b16 v[32:33], v19 offset:16384
    v_mfma_f32_16x16x32_bf16 v[116:119], v[68:71], v[84:87], v[116:119]
    ds_read_b64_tr_b16 v[34:35], v19 offset:20480
    v_mfma_f32_16x16x32_bf16 v[120:123], v[68:71], v[88:91], v[120:123]
    ds_read_b64_tr_b16 v[36:37], v20 offset:16384
    v_mfma_f32_16x16x32_bf16 v[124:127], v[68:71], v[92:95], v[124:127]
    ds_read_b64_tr_b16 v[38:39], v20 offset:20480
    s_waitcnt lgkmcnt(10)
    v_mfma_f32_16x16x32_bf16 v[128:131], v[72:75], v[80:83], v[128:131]
    ds_read_b64_tr_b16 v[40:41], v21 offset:16384
    v_mfma_f32_16x16x32_bf16 v[132:135], v[72:75], v[84:87], v[132:135]
    ds_read_b64_tr_b16 v[42:43], v21 offset:20480
    v_mfma_f32_16x16x32_bf16 v[136:139], v[72:75], v[88:91], v[136:139]
    ds_read_b64_tr_b16 v[44:45], v22 offset:16384
    v_mfma_f32_16x16x32_bf16 v[140:143], v[72:75], v[92:95], v[140:143]
    ds_read_b64_tr_b16 v[46:47], v22 offset:20480
    s_waitcnt lgkmcnt(12)
    v_mfma_f32_16x16x32_bf16 v[144:147], v[76:79], v[80:83], v[144:147]
    v_mfma_f32_16x16x32_bf16 v[148:151], v[76:79], v[84:87], v[148:151]
    v_mfma_f32_16x16x32_bf16 v[152:155], v[76:79], v[88:91], v[152:155]
    v_mfma_f32_16x16x32_bf16 v[156:159], v[76:79], v[92:95], v[156:159]
    s_waitcnt lgkmcnt(6)
    v_mfma_f32_16x16x32_bf16 v[96:99], v[32:35], v[48:51], v[96:99]
    ds_read_b128 v[80:83], v25 offset:1024
    v_mfma_f32_16x16x32_bf16 v[100:103], v[32:35], v[52:55], v[100:103]
    ds_read_b128 v[84:87], v25 offset:3072
    v_mfma_f32_16x16x32_bf16 v[104:107], v[32:35], v[56:59], v[104:107]
    ds_read_b128 v[88:91], v25 offset:5120
    v_mfma_f32_16x16x32_bf16 v[108:111], v[32:35], v[60:63], v[108:111]
    ds_read_b128 v[92:95], v25 offset:7168
    s_waitcnt lgkmcnt(8)
    v_mfma_f32_16x16x32_bf16 v[112:115], v[36:39], v[48:51], v[112:115]
    ds_read_b64_tr_b16 v[64:65], v19 offset:24576
    v_mfma_f32_16x16x32_bf16 v[116:119], v[36:39], v[52:55], v[116:119]
    ds_read_b64_tr_b16 v[66:67], v19 offset:28672
    v_mfma_f32_16x16x32_bf16 v[120:123], v[36:39], v[56:59], v[120:123]
    ds_read_b64_tr_b16 v[68:69], v20 offset:24576
    v_mfma_f32_16x16x32_bf16 v[124:127], v[36:39], v[60:63], v[124:127]
    ds_read_b64_tr_b16 v[70:71], v20 offset:28672
    s_waitcnt lgkmcnt(10)
    v_mfma_f32_16x16x32_bf16 v[128:131], v[40:43], v[48:51], v[128:131]
    ds_read_b64_tr_b16 v[72:73], v21 offset:24576
    v_mfma_f32_16x16x32_bf16 v[132:135], v[40:43], v[52:55], v[132:135]
    ds_read_b64_tr_b16 v[74:75], v21 offset:28672
    v_mfma_f32_16x16x32_bf16 v[136:139], v[40:43], v[56:59], v[136:139]
    ds_read_b64_tr_b16 v[76:77], v22 offset:24576
    v_mfma_f32_16x16x32_bf16 v[140:143], v[40:43], v[60:63], v[140:143]
    ds_read_b64_tr_b16 v[78:79], v22 offset:28672
    s_waitcnt lgkmcnt(12)
    v_mfma_f32_16x16x32_bf16 v[144:147], v[44:47], v[48:51], v[144:147]
    v_mfma_f32_16x16x32_bf16 v[148:151], v[44:47], v[52:55], v[148:151]
    v_mfma_f32_16x16x32_bf16 v[152:155], v[44:47], v[56:59], v[152:155]
    v_mfma_f32_16x16x32_bf16 v[156:159], v[44:47], v[60:63], v[156:159]
    s_barrier
    s_waitcnt lgkmcnt(6)
    v_mfma_f32_16x16x32_bf16 v[96:99], v[64:67], v[80:83], v[96:99]
    ds_read_b128 v[48:51], v23 offset:0
    v_mfma_f32_16x16x32_bf16 v[100:103], v[64:67], v[84:87], v[100:103]
    ds_read_b128 v[52:55], v23 offset:2048
    v_mfma_f32_16x16x32_bf16 v[104:107], v[64:67], v[88:91], v[104:107]
    ds_read_b128 v[56:59], v23 offset:4096
    v_mfma_f32_16x16x32_bf16 v[108:111], v[64:67], v[92:95], v[108:111]
    ds_read_b128 v[60:63], v23 offset:6144
    s_waitcnt lgkmcnt(8)
    v_mfma_f32_16x16x32_bf16 v[112:115], v[68:71], v[80:83], v[112:115]
    ds_read_b64_tr_b16 v[32:33], v11 offset:16384
    v_mfma_f32_16x16x32_bf16 v[116:119], v[68:71], v[84:87], v[116:119]
    ds_read_b64_tr_b16 v[34:35], v11 offset:20480
    v_mfma_f32_16x16x32_bf16 v[120:123], v[68:71], v[88:91], v[120:123]
    ds_read_b64_tr_b16 v[36:37], v12 offset:16384
    v_mfma_f32_16x16x32_bf16 v[124:127], v[68:71], v[92:95], v[124:127]
    ds_read_b64_tr_b16 v[38:39], v12 offset:20480
    s_waitcnt lgkmcnt(10)
    v_mfma_f32_16x16x32_bf16 v[128:131], v[72:75], v[80:83], v[128:131]
    ds_read_b64_tr_b16 v[40:41], v13 offset:16384
    v_mfma_f32_16x16x32_bf16 v[132:135], v[72:75], v[84:87], v[132:135]
    ds_read_b64_tr_b16 v[42:43], v13 offset:20480
    v_mfma_f32_16x16x32_bf16 v[136:139], v[72:75], v[88:91], v[136:139]
    ds_read_b64_tr_b16 v[44:45], v14 offset:16384
    v_mfma_f32_16x16x32_bf16 v[140:143], v[72:75], v[92:95], v[140:143]
    ds_read_b64_tr_b16 v[46:47], v14 offset:20480
    s_waitcnt lgkmcnt(12)
    v_mfma_f32_16x16x32_bf16 v[144:147], v[76:79], v[80:83], v[144:147]
    v_mfma_f32_16x16x32_bf16 v[148:151], v[76:79], v[84:87], v[148:151]
    v_mfma_f32_16x16x32_bf16 v[152:155], v[76:79], v[88:91], v[152:155]
    v_mfma_f32_16x16x32_bf16 v[156:159], v[76:79], v[92:95], v[156:159]
    s_waitcnt lgkmcnt(6)
    v_mfma_f32_16x16x32_bf16 v[96:99], v[32:35], v[48:51], v[96:99]
    ds_read_b128 v[80:83], v23 offset:1024
    v_mfma_f32_16x16x32_bf16 v[100:103], v[32:35], v[52:55], v[100:103]
    ds_read_b128 v[84:87], v23 offset:3072
    v_mfma_f32_16x16x32_bf16 v[104:107], v[32:35], v[56:59], v[104:107]
    ds_read_b128 v[88:91], v23 offset:5120
    v_mfma_f32_16x16x32_bf16 v[108:111], v[32:35], v[60:63], v[108:111]
    ds_read_b128 v[92:95], v23 offset:7168
    s_waitcnt lgkmcnt(8)
    v_mfma_f32_16x16x32_bf16 v[112:115], v[36:39], v[48:51], v[112:115]
    ds_read_b64_tr_b16 v[64:65], v11 offset:24576
    v_mfma_f32_16x16x32_bf16 v[116:119], v[36:39], v[52:55], v[116:119]
    ds_read_b64_tr_b16 v[66:67], v11 offset:28672
    v_mfma_f32_16x16x32_bf16 v[120:123], v[36:39], v[56:59], v[120:123]
    ds_read_b64_tr_b16 v[68:69], v12 offset:24576
    v_mfma_f32_16x16x32_bf16 v[124:127], v[36:39], v[60:63], v[124:127]
    ds_read_b64_tr_b16 v[70:71], v12 offset:28672
    s_waitcnt lgkmcnt(10)
    v_mfma_f32_16x16x32_bf16 v[128:131], v[40:43], v[48:51], v[128:131]
    ds_read_b64_tr_b16 v[72:73], v13 offset:24576
    v_mfma_f32_16x16x32_bf16 v[132:135], v[40:43], v[52:55], v[132:135]
    ds_read_b64_tr_b16 v[74:75], v13 offset:28672
    v_mfma_f32_16x16x32_bf16 v[136:139], v[40:43], v[56:59], v[136:139]
    ds_read_b64_tr_b16 v[76:77], v14 offset:24576
    v_mfma_f32_16x16x32_bf16 v[140:143], v[40:43], v[60:63], v[140:143]
    ds_read_b64_tr_b16 v[78:79], v14 offset:28672
    s_waitcnt lgkmcnt(12)
    v_mfma_f32_16x16x32_bf16 v[144:147], v[44:47], v[48:51], v[144:147]
    v_mfma_f32_16x16x32_bf16 v[148:151], v[44:47], v[52:55], v[148:151]
    v_mfma_f32_16x16x32_bf16 v[152:155], v[44:47], v[56:59], v[152:155]
    v_mfma_f32_16x16x32_bf16 v[156:159], v[44:47], v[60:63], v[156:159]
    s_barrier
    s_waitcnt lgkmcnt(6)
    v_mfma_f32_16x16x32_bf16 v[96:99], v[64:67], v[80:83], v[96:99]
    ds_read_b128 v[48:51], v23 offset:32768
    v_mfma_f32_16x16x32_bf16 v[100:103], v[64:67], v[84:87], v[100:103]
    ds_read_b128 v[52:55], v23 offset:34816
    v_mfma_f32_16x16x32_bf16 v[104:107], v[64:67], v[88:91], v[104:107]
    ds_read_b128 v[56:59], v23 offset:36864
    v_mfma_f32_16x16x32_bf16 v[108:111], v[64:67], v[92:95], v[108:111]
    ds_read_b128 v[60:63], v23 offset:38912
    s_waitcnt lgkmcnt(8)
    v_mfma_f32_16x16x32_bf16 v[112:115], v[68:71], v[80:83], v[112:115]
    ds_read_b64_tr_b16 v[32:33], v11 offset:49152
    v_mfma_f32_16x16x32_bf16 v[116:119], v[68:71], v[84:87], v[116:119]
    ds_read_b64_tr_b16 v[34:35], v11 offset:53248
    v_mfma_f32_16x16x32_bf16 v[120:123], v[68:71], v[88:91], v[120:123]
    ds_read_b64_tr_b16 v[36:37], v12 offset:49152
    v_mfma_f32_16x16x32_bf16 v[124:127], v[68:71], v[92:95], v[124:127]
    ds_read_b64_tr_b16 v[38:39], v12 offset:53248
    s_waitcnt lgkmcnt(10)
    v_mfma_f32_16x16x32_bf16 v[128:131], v[72:75], v[80:83], v[128:131]
    ds_read_b64_tr_b16 v[40:41], v13 offset:49152
    v_mfma_f32_16x16x32_bf16 v[132:135], v[72:75], v[84:87], v[132:135]
    ds_read_b64_tr_b16 v[42:43], v13 offset:53248
    v_mfma_f32_16x16x32_bf16 v[136:139], v[72:75], v[88:91], v[136:139]
    ds_read_b64_tr_b16 v[44:45], v14 offset:49152
    v_mfma_f32_16x16x32_bf16 v[140:143], v[72:75], v[92:95], v[140:143]
    ds_read_b64_tr_b16 v[46:47], v14 offset:53248
    s_waitcnt lgkmcnt(12)
    v_mfma_f32_16x16x32_bf16 v[144:147], v[76:79], v[80:83], v[144:147]
    v_mfma_f32_16x16x32_bf16 v[148:151], v[76:79], v[84:87], v[148:151]
    v_mfma_f32_16x16x32_bf16 v[152:155], v[76:79], v[88:91], v[152:155]
    v_mfma_f32_16x16x32_bf16 v[156:159], v[76:79], v[92:95], v[156:159]
    s_waitcnt lgkmcnt(6)
    v_mfma_f32_16x16x32_bf16 v[96:99], v[32:35], v[48:51], v[96:99]
    ds_read_b128 v[80:83], v23 offset:33792
    v_mfma_f32_16x16x32_bf16 v[100:103], v[32:35], v[52:55], v[100:103]
    ds_read_b128 v[84:87], v23 offset:35840
    v_mfma_f32_16x16x32_bf16 v[104:107], v[32:35], v[56:59], v[104:107]
    ds_read_b128 v[88:91], v23 offset:37888
    v_mfma_f32_16x16x32_bf16 v[108:111], v[32:35], v[60:63], v[108:111]
    ds_read_b128 v[92:95], v23 offset:39936
    s_waitcnt lgkmcnt(8)
    v_mfma_f32_16x16x32_bf16 v[112:115], v[36:39], v[48:51], v[112:115]
    ds_read_b64_tr_b16 v[64:65], v11 offset:57344
    v_mfma_f32_16x16x32_bf16 v[116:119], v[36:39], v[52:55], v[116:119]
    ds_read_b64_tr_b16 v[66:67], v11 offset:61440
    v_mfma_f32_16x16x32_bf16 v[120:123], v[36:39], v[56:59], v[120:123]
    ds_read_b64_tr_b16 v[68:69], v12 offset:57344
    v_mfma_f32_16x16x32_bf16 v[124:127], v[36:39], v[60:63], v[124:127]
    ds_read_b64_tr_b16 v[70:71], v12 offset:61440
    s_waitcnt lgkmcnt(10)
    v_mfma_f32_16x16x32_bf16 v[128:131], v[40:43], v[48:51], v[128:131]
    ds_read_b64_tr_b16 v[72:73], v13 offset:57344
    v_mfma_f32_16x16x32_bf16 v[132:135], v[40:43], v[52:55], v[132:135]
    ds_read_b64_tr_b16 v[74:75], v13 offset:61440
    v_mfma_f32_16x16x32_bf16 v[136:139], v[40:43], v[56:59], v[136:139]
    ds_read_b64_tr_b16 v[76:77], v14 offset:57344
    v_mfma_f32_16x16x32_bf16 v[140:143], v[40:43], v[60:63], v[140:143]
    ds_read_b64_tr_b16 v[78:79], v14 offset:61440
    s_waitcnt lgkmcnt(12)
    v_mfma_f32_16x16x32_bf16 v[144:147], v[44:47], v[48:51], v[144:147]
    v_mfma_f32_16x16x32_bf16 v[148:151], v[44:47], v[52:55], v[148:151]
    v_mfma_f32_16x16x32_bf16 v[152:155], v[44:47], v[56:59], v[152:155]
    v_mfma_f32_16x16x32_bf16 v[156:159], v[44:47], v[60:63], v[156:159]
    s_barrier
    s_waitcnt lgkmcnt(6)
    v_mfma_f32_16x16x32_bf16 v[96:99], v[64:67], v[80:83], v[96:99]
    ds_read_b128 v[48:51], v24 offset:0
    v_mfma_f32_16x16x32_bf16 v[100:103], v[64:67], v[84:87], v[100:103]
    ds_read_b128 v[52:55], v24 offset:2048
    v_mfma_f32_16x16x32_bf16 v[104:107], v[64:67], v[88:91], v[104:107]
    ds_read_b128 v[56:59], v24 offset:4096
    v_mfma_f32_16x16x32_bf16 v[108:111], v[64:67], v[92:95], v[108:111]
    ds_read_b128 v[60:63], v24 offset:6144
    s_waitcnt lgkmcnt(8)
    v_mfma_f32_16x16x32_bf16 v[112:115], v[68:71], v[80:83], v[112:115]
    ds_read_b64_tr_b16 v[32:33], v15 offset:16384
    v_mfma_f32_16x16x32_bf16 v[116:119], v[68:71], v[84:87], v[116:119]
    ds_read_b64_tr_b16 v[34:35], v15 offset:20480
    v_mfma_f32_16x16x32_bf16 v[120:123], v[68:71], v[88:91], v[120:123]
    ds_read_b64_tr_b16 v[36:37], v16 offset:16384
    v_mfma_f32_16x16x32_bf16 v[124:127], v[68:71], v[92:95], v[124:127]
    ds_read_b64_tr_b16 v[38:39], v16 offset:20480
    s_waitcnt lgkmcnt(10)
    v_mfma_f32_16x16x32_bf16 v[128:131], v[72:75], v[80:83], v[128:131]
    ds_read_b64_tr_b16 v[40:41], v17 offset:16384
    v_mfma_f32_16x16x32_bf16 v[132:135], v[72:75], v[84:87], v[132:135]
    ds_read_b64_tr_b16 v[42:43], v17 offset:20480
    v_mfma_f32_16x16x32_bf16 v[136:139], v[72:75], v[88:91], v[136:139]
    ds_read_b64_tr_b16 v[44:45], v18 offset:16384
    v_mfma_f32_16x16x32_bf16 v[140:143], v[72:75], v[92:95], v[140:143]
    ds_read_b64_tr_b16 v[46:47], v18 offset:20480
    s_waitcnt lgkmcnt(12)
    v_mfma_f32_16x16x32_bf16 v[144:147], v[76:79], v[80:83], v[144:147]
    v_mfma_f32_16x16x32_bf16 v[148:151], v[76:79], v[84:87], v[148:151]
    v_mfma_f32_16x16x32_bf16 v[152:155], v[76:79], v[88:91], v[152:155]
    v_mfma_f32_16x16x32_bf16 v[156:159], v[76:79], v[92:95], v[156:159]
    s_waitcnt lgkmcnt(6)
    v_mfma_f32_16x16x32_bf16 v[96:99], v[32:35], v[48:51], v[96:99]
    ds_read_b128 v[80:83], v24 offset:1024
    v_mfma_f32_16x16x32_bf16 v[100:103], v[32:35], v[52:55], v[100:103]
    ds_read_b128 v[84:87], v24 offset:3072
    v_mfma_f32_16x16x32_bf16 v[104:107], v[32:35], v[56:59], v[104:107]
    ds_read_b128 v[88:91], v24 offset:5120
    v_mfma_f32_16x16x32_bf16 v[108:111], v[32:35], v[60:63], v[108:111]
    ds_read_b128 v[92:95], v24 offset:7168
    s_waitcnt lgkmcnt(8)
    v_mfma_f32_16x16x32_bf16 v[112:115], v[36:39], v[48:51], v[112:115]
    ds_read_b64_tr_b16 v[64:65], v15 offset:24576
    v_mfma_f32_16x16x32_bf16 v[116:119], v[36:39], v[52:55], v[116:119]
    ds_read_b64_tr_b16 v[66:67], v15 offset:28672
    v_mfma_f32_16x16x32_bf16 v[120:123], v[36:39], v[56:59], v[120:123]
    ds_read_b64_tr_b16 v[68:69], v16 offset:24576
    v_mfma_f32_16x16x32_bf16 v[124:127], v[36:39], v[60:63], v[124:127]
    ds_read_b64_tr_b16 v[70:71], v16 offset:28672
    s_waitcnt lgkmcnt(10)
    v_mfma_f32_16x16x32_bf16 v[128:131], v[40:43], v[48:51], v[128:131]
    ds_read_b64_tr_b16 v[72:73], v17 offset:24576
    v_mfma_f32_16x16x32_bf16 v[132:135], v[40:43], v[52:55], v[132:135]
    ds_read_b64_tr_b16 v[74:75], v17 offset:28672
    v_mfma_f32_16x16x32_bf16 v[136:139], v[40:43], v[56:59], v[136:139]
    ds_read_b64_tr_b16 v[76:77], v18 offset:24576
    v_mfma_f32_16x16x32_bf16 v[140:143], v[40:43], v[60:63], v[140:143]
    ds_read_b64_tr_b16 v[78:79], v18 offset:28672
    s_waitcnt lgkmcnt(12)
    v_mfma_f32_16x16x32_bf16 v[144:147], v[44:47], v[48:51], v[144:147]
    v_mfma_f32_16x16x32_bf16 v[148:151], v[44:47], v[52:55], v[148:151]
    v_mfma_f32_16x16x32_bf16 v[152:155], v[44:47], v[56:59], v[152:155]
    v_mfma_f32_16x16x32_bf16 v[156:159], v[44:47], v[60:63], v[156:159]
    s_barrier
    s_waitcnt lgkmcnt(6)
    v_mfma_f32_16x16x32_bf16 v[96:99], v[64:67], v[80:83], v[96:99]
    ds_read_b128 v[48:51], v24 offset:32768
    v_mfma_f32_16x16x32_bf16 v[100:103], v[64:67], v[84:87], v[100:103]
    ds_read_b128 v[52:55], v24 offset:34816
    v_mfma_f32_16x16x32_bf16 v[104:107], v[64:67], v[88:91], v[104:107]
    ds_read_b128 v[56:59], v24 offset:36864
    v_mfma_f32_16x16x32_bf16 v[108:111], v[64:67], v[92:95], v[108:111]
    ds_read_b128 v[60:63], v24 offset:38912
    s_waitcnt lgkmcnt(8)
    v_mfma_f32_16x16x32_bf16 v[112:115], v[68:71], v[80:83], v[112:115]
    ds_read_b64_tr_b16 v[32:33], v15 offset:49152
    v_mfma_f32_16x16x32_bf16 v[116:119], v[68:71], v[84:87], v[116:119]
    ds_read_b64_tr_b16 v[34:35], v15 offset:53248
    v_mfma_f32_16x16x32_bf16 v[120:123], v[68:71], v[88:91], v[120:123]
    ds_read_b64_tr_b16 v[36:37], v16 offset:49152
    v_mfma_f32_16x16x32_bf16 v[124:127], v[68:71], v[92:95], v[124:127]
    ds_read_b64_tr_b16 v[38:39], v16 offset:53248
    s_waitcnt lgkmcnt(10)
    v_mfma_f32_16x16x32_bf16 v[128:131], v[72:75], v[80:83], v[128:131]
    ds_read_b64_tr_b16 v[40:41], v17 offset:49152
    v_mfma_f32_16x16x32_bf16 v[132:135], v[72:75], v[84:87], v[132:135]
    ds_read_b64_tr_b16 v[42:43], v17 offset:53248
    v_mfma_f32_16x16x32_bf16 v[136:139], v[72:75], v[88:91], v[136:139]
    ds_read_b64_tr_b16 v[44:45], v18 offset:49152
    v_mfma_f32_16x16x32_bf16 v[140:143], v[72:75], v[92:95], v[140:143]
    ds_read_b64_tr_b16 v[46:47], v18 offset:53248
    s_waitcnt lgkmcnt(12)
    v_mfma_f32_16x16x32_bf16 v[144:147], v[76:79], v[80:83], v[144:147]
    v_mfma_f32_16x16x32_bf16 v[148:151], v[76:79], v[84:87], v[148:151]
    v_mfma_f32_16x16x32_bf16 v[152:155], v[76:79], v[88:91], v[152:155]
    v_mfma_f32_16x16x32_bf16 v[156:159], v[76:79], v[92:95], v[156:159]
    s_waitcnt lgkmcnt(6)
    v_mfma_f32_16x16x32_bf16 v[96:99], v[32:35], v[48:51], v[96:99]
    ds_read_b128 v[80:83], v24 offset:33792
    v_mfma_f32_16x16x32_bf16 v[100:103], v[32:35], v[52:55], v[100:103]
    ds_read_b128 v[84:87], v24 offset:35840
    v_mfma_f32_16x16x32_bf16 v[104:107], v[32:35], v[56:59], v[104:107]
    ds_read_b128 v[88:91], v24 offset:37888
    v_mfma_f32_16x16x32_bf16 v[108:111], v[32:35], v[60:63], v[108:111]
    ds_read_b128 v[92:95], v24 offset:39936
    s_waitcnt lgkmcnt(8)
    v_mfma_f32_16x16x32_bf16 v[112:115], v[36:39], v[48:51], v[112:115]
    ds_read_b64_tr_b16 v[64:65], v15 offset:57344
    v_mfma_f32_16x16x32_bf16 v[116:119], v[36:39], v[52:55], v[116:119]
    ds_read_b64_tr_b16 v[66:67], v15 offset:61440
    v_mfma_f32_16x16x32_bf16 v[120:123], v[36:39], v[56:59], v[120:123]
    ds_read_b64_tr_b16 v[68:69], v16 offset:57344
    v_mfma_f32_16x16x32_bf16 v[124:127], v[36:39], v[60:63], v[124:127]
    ds_read_b64_tr_b16 v[70:71], v16 offset:61440
    s_waitcnt lgkmcnt(10)
    v_mfma_f32_16x16x32_bf16 v[128:131], v[40:43], v[48:51], v[128:131]
    ds_read_b64_tr_b16 v[72:73], v17 offset:57344
    v_mfma_f32_16x16x32_bf16 v[132:135], v[40:43], v[52:55], v[132:135]
    ds_read_b64_tr_b16 v[74:75], v17 offset:61440
    v_mfma_f32_16x16x32_bf16 v[136:139], v[40:43], v[56:59], v[136:139]
    ds_read_b64_tr_b16 v[76:77], v18 offset:57344
    v_mfma_f32_16x16x32_bf16 v[140:143], v[40:43], v[60:63], v[140:143]
    ds_read_b64_tr_b16 v[78:79], v18 offset:61440
    s_waitcnt lgkmcnt(12)
    v_mfma_f32_16x16x32_bf16 v[144:147], v[44:47], v[48:51], v[144:147]
    v_mfma_f32_16x16x32_bf16 v[148:151], v[44:47], v[52:55], v[148:151]
    v_mfma_f32_16x16x32_bf16 v[152:155], v[44:47], v[56:59], v[152:155]
    v_mfma_f32_16x16x32_bf16 v[156:159], v[44:47], v[60:63], v[156:159]
    s_barrier
    s_waitcnt lgkmcnt(6)
    v_mfma_f32_16x16x32_bf16 v[96:99], v[64:67], v[80:83], v[96:99]
    ds_read_b128 v[48:51], v25 offset:0
    v_mfma_f32_16x16x32_bf16 v[100:103], v[64:67], v[84:87], v[100:103]
    ds_read_b128 v[52:55], v25 offset:2048
    v_mfma_f32_16x16x32_bf16 v[104:107], v[64:67], v[88:91], v[104:107]
    ds_read_b128 v[56:59], v25 offset:4096
    v_mfma_f32_16x16x32_bf16 v[108:111], v[64:67], v[92:95], v[108:111]
    ds_read_b128 v[60:63], v25 offset:6144
    s_waitcnt lgkmcnt(8)
    v_mfma_f32_16x16x32_bf16 v[112:115], v[68:71], v[80:83], v[112:115]
    ds_read_b64_tr_b16 v[32:33], v19 offset:16384
    v_mfma_f32_16x16x32_bf16 v[116:119], v[68:71], v[84:87], v[116:119]
    ds_read_b64_tr_b16 v[34:35], v19 offset:20480
    v_mfma_f32_16x16x32_bf16 v[120:123], v[68:71], v[88:91], v[120:123]
    ds_read_b64_tr_b16 v[36:37], v20 offset:16384
    v_mfma_f32_16x16x32_bf16 v[124:127], v[68:71], v[92:95], v[124:127]
    ds_read_b64_tr_b16 v[38:39], v20 offset:20480
    s_waitcnt lgkmcnt(10)
    v_mfma_f32_16x16x32_bf16 v[128:131], v[72:75], v[80:83], v[128:131]
    ds_read_b64_tr_b16 v[40:41], v21 offset:16384
    v_mfma_f32_16x16x32_bf16 v[132:135], v[72:75], v[84:87], v[132:135]
    ds_read_b64_tr_b16 v[42:43], v21 offset:20480
    v_mfma_f32_16x16x32_bf16 v[136:139], v[72:75], v[88:91], v[136:139]
    ds_read_b64_tr_b16 v[44:45], v22 offset:16384
    v_mfma_f32_16x16x32_bf16 v[140:143], v[72:75], v[92:95], v[140:143]
    ds_read_b64_tr_b16 v[46:47], v22 offset:20480
    s_waitcnt lgkmcnt(12)
    v_mfma_f32_16x16x32_bf16 v[144:147], v[76:79], v[80:83], v[144:147]
    v_mfma_f32_16x16x32_bf16 v[148:151], v[76:79], v[84:87], v[148:151]
    v_mfma_f32_16x16x32_bf16 v[152:155], v[76:79], v[88:91], v[152:155]
    v_mfma_f32_16x16x32_bf16 v[156:159], v[76:79], v[92:95], v[156:159]
    s_waitcnt lgkmcnt(6)
    v_mfma_f32_16x16x32_bf16 v[96:99], v[32:35], v[48:51], v[96:99]
    ds_read_b128 v[80:83], v25 offset:1024
    v_mfma_f32_16x16x32_bf16 v[100:103], v[32:35], v[52:55], v[100:103]
    ds_read_b128 v[84:87], v25 offset:3072
    v_mfma_f32_16x16x32_bf16 v[104:107], v[32:35], v[56:59], v[104:107]
    ds_read_b128 v[88:91], v25 offset:5120
    v_mfma_f32_16x16x32_bf16 v[108:111], v[32:35], v[60:63], v[108:111]
    ds_read_b128 v[92:95], v25 offset:7168
    s_waitcnt lgkmcnt(8)
    v_mfma_f32_16x16x32_bf16 v[112:115], v[36:39], v[48:51], v[112:115]
    ds_read_b64_tr_b16 v[64:65], v19 offset:24576
    v_mfma_f32_16x16x32_bf16 v[116:119], v[36:39], v[52:55], v[116:119]
    ds_read_b64_tr_b16 v[66:67], v19 offset:28672
    v_mfma_f32_16x16x32_bf16 v[120:123], v[36:39], v[56:59], v[120:123]
    ds_read_b64_tr_b16 v[68:69], v20 offset:24576
    v_mfma_f32_16x16x32_bf16 v[124:127], v[36:39], v[60:63], v[124:127]
    ds_read_b64_tr_b16 v[70:71], v20 offset:28672
    s_waitcnt lgkmcnt(10)
    v_mfma_f32_16x16x32_bf16 v[128:131], v[40:43], v[48:51], v[128:131]
    ds_read_b64_tr_b16 v[72:73], v21 offset:24576
    v_mfma_f32_16x16x32_bf16 v[132:135], v[40:43], v[52:55], v[132:135]
    ds_read_b64_tr_b16 v[74:75], v21 offset:28672
    v_mfma_f32_16x16x32_bf16 v[136:139], v[40:43], v[56:59], v[136:139]
    ds_read_b64_tr_b16 v[76:77], v22 offset:24576
    v_mfma_f32_16x16x32_bf16 v[140:143], v[40:43], v[60:63], v[140:143]
    ds_read_b64_tr_b16 v[78:79], v22 offset:28672
    s_waitcnt lgkmcnt(12)
    v_mfma_f32_16x16x32_bf16 v[144:147], v[44:47], v[48:51], v[144:147]
    v_mfma_f32_16x16x32_bf16 v[148:151], v[44:47], v[52:55], v[148:151]
    v_mfma_f32_16x16x32_bf16 v[152:155], v[44:47], v[56:59], v[152:155]
    v_mfma_f32_16x16x32_bf16 v[156:159], v[44:47], v[60:63], v[156:159]
    s_barrier
    s_waitcnt lgkmcnt(6)
    v_mfma_f32_16x16x32_bf16 v[96:99], v[64:67], v[80:83], v[96:99]
    ds_read_b128 v[48:51], v23 offset:0
    v_mfma_f32_16x16x32_bf16 v[100:103], v[64:67], v[84:87], v[100:103]
    ds_read_b128 v[52:55], v23 offset:2048
    v_mfma_f32_16x16x32_bf16 v[104:107], v[64:67], v[88:91], v[104:107]
    ds_read_b128 v[56:59], v23 offset:4096
    v_mfma_f32_16x16x32_bf16 v[108:111], v[64:67], v[92:95], v[108:111]
    ds_read_b128 v[60:63], v23 offset:6144
    s_waitcnt lgkmcnt(8)
    v_mfma_f32_16x16x32_bf16 v[112:115], v[68:71], v[80:83], v[112:115]
    ds_read_b64_tr_b16 v[32:33], v11 offset:16384
    v_mfma_f32_16x16x32_bf16 v[116:119], v[68:71], v[84:87], v[116:119]
    ds_read_b64_tr_b16 v[34:35], v11 offset:20480
    v_mfma_f32_16x16x32_bf16 v[120:123], v[68:71], v[88:91], v[120:123]
    ds_read_b64_tr_b16 v[36:37], v12 offset:16384
    v_mfma_f32_16x16x32_bf16 v[124:127], v[68:71], v[92:95], v[124:127]
    ds_read_b64_tr_b16 v[38:39], v12 offset:20480
    s_waitcnt lgkmcnt(10)
    v_mfma_f32_16x16x32_bf16 v[128:131], v[72:75], v[80:83], v[128:131]
    ds_read_b64_tr_b16 v[40:41], v13 offset:16384
    v_mfma_f32_16x16x32_bf16 v[132:135], v[72:75], v[84:87], v[132:135]
    ds_read_b64_tr_b16 v[42:43], v13 offset:20480
    v_mfma_f32_16x16x32_bf16 v[136:139], v[72:75], v[88:91], v[136:139]
    ds_read_b64_tr_b16 v[44:45], v14 offset:16384
    v_mfma_f32_16x16x32_bf16 v[140:143], v[72:75], v[92:95], v[140:143]
    ds_read_b64_tr_b16 v[46:47], v14 offset:20480
    s_waitcnt lgkmcnt(12)
    v_mfma_f32_16x16x32_bf16 v[144:147], v[76:79], v[80:83], v[144:147]
    v_mfma_f32_16x16x32_bf16 v[148:151], v[76:79], v[84:87], v[148:151]
    v_mfma_f32_16x16x32_bf16 v[152:155], v[76:79], v[88:91], v[152:155]
    v_mfma_f32_16x16x32_bf16 v[156:159], v[76:79], v[92:95], v[156:159]
    s_waitcnt lgkmcnt(6)
    v_mfma_f32_16x16x32_bf16 v[96:99], v[32:35], v[48:51], v[96:99]
    ds_read_b128 v[80:83], v23 offset:1024
    v_mfma_f32_16x16x32_bf16 v[100:103], v[32:35], v[52:55], v[100:103]
    ds_read_b128 v[84:87], v23 offset:3072
    v_mfma_f32_16x16x32_bf16 v[104:107], v[32:35], v[56:59], v[104:107]
    ds_read_b128 v[88:91], v23 offset:5120
    v_mfma_f32_16x16x32_bf16 v[108:111], v[32:35], v[60:63], v[108:111]
    ds_read_b128 v[92:95], v23 offset:7168
    s_waitcnt lgkmcnt(8)
    v_mfma_f32_16x16x32_bf16 v[112:115], v[36:39], v[48:51], v[112:115]
    ds_read_b64_tr_b16 v[64:65], v11 offset:24576
    v_mfma_f32_16x16x32_bf16 v[116:119], v[36:39], v[52:55], v[116:119]
    ds_read_b64_tr_b16 v[66:67], v11 offset:28672
    v_mfma_f32_16x16x32_bf16 v[120:123], v[36:39], v[56:59], v[120:123]
    ds_read_b64_tr_b16 v[68:69], v12 offset:24576
    v_mfma_f32_16x16x32_bf16 v[124:127], v[36:39], v[60:63], v[124:127]
    ds_read_b64_tr_b16 v[70:71], v12 offset:28672
    s_waitcnt lgkmcnt(10)
    v_mfma_f32_16x16x32_bf16 v[128:131], v[40:43], v[48:51], v[128:131]
    ds_read_b64_tr_b16 v[72:73], v13 offset:24576
    v_mfma_f32_16x16x32_bf16 v[132:135], v[40:43], v[52:55], v[132:135]
    ds_read_b64_tr_b16 v[74:75], v13 offset:28672
    v_mfma_f32_16x16x32_bf16 v[136:139], v[40:43], v[56:59], v[136:139]
    ds_read_b64_tr_b16 v[76:77], v14 offset:24576
    v_mfma_f32_16x16x32_bf16 v[140:143], v[40:43], v[60:63], v[140:143]
    ds_read_b64_tr_b16 v[78:79], v14 offset:28672
    s_waitcnt lgkmcnt(12)
    v_mfma_f32_16x16x32_bf16 v[144:147], v[44:47], v[48:51], v[144:147]
    v_mfma_f32_16x16x32_bf16 v[148:151], v[44:47], v[52:55], v[148:151]
    v_mfma_f32_16x16x32_bf16 v[152:155], v[44:47], v[56:59], v[152:155]
    v_mfma_f32_16x16x32_bf16 v[156:159], v[44:47], v[60:63], v[156:159]
    s_barrier
    s_waitcnt lgkmcnt(6)
    v_mfma_f32_16x16x32_bf16 v[96:99], v[64:67], v[80:83], v[96:99]
    ds_read_b128 v[48:51], v23 offset:32768
    v_mfma_f32_16x16x32_bf16 v[100:103], v[64:67], v[84:87], v[100:103]
    ds_read_b128 v[52:55], v23 offset:34816
    v_mfma_f32_16x16x32_bf16 v[104:107], v[64:67], v[88:91], v[104:107]
    ds_read_b128 v[56:59], v23 offset:36864
    v_mfma_f32_16x16x32_bf16 v[108:111], v[64:67], v[92:95], v[108:111]
    ds_read_b128 v[60:63], v23 offset:38912
    s_waitcnt lgkmcnt(8)
    v_mfma_f32_16x16x32_bf16 v[112:115], v[68:71], v[80:83], v[112:115]
    ds_read_b64_tr_b16 v[32:33], v11 offset:49152
    v_mfma_f32_16x16x32_bf16 v[116:119], v[68:71], v[84:87], v[116:119]
    ds_read_b64_tr_b16 v[34:35], v11 offset:53248
    v_mfma_f32_16x16x32_bf16 v[120:123], v[68:71], v[88:91], v[120:123]
    ds_read_b64_tr_b16 v[36:37], v12 offset:49152
    v_mfma_f32_16x16x32_bf16 v[124:127], v[68:71], v[92:95], v[124:127]
    ds_read_b64_tr_b16 v[38:39], v12 offset:53248
    s_waitcnt lgkmcnt(10)
    v_mfma_f32_16x16x32_bf16 v[128:131], v[72:75], v[80:83], v[128:131]
    ds_read_b64_tr_b16 v[40:41], v13 offset:49152
    v_mfma_f32_16x16x32_bf16 v[132:135], v[72:75], v[84:87], v[132:135]
    ds_read_b64_tr_b16 v[42:43], v13 offset:53248
    v_mfma_f32_16x16x32_bf16 v[136:139], v[72:75], v[88:91], v[136:139]
    ds_read_b64_tr_b16 v[44:45], v14 offset:49152
    v_mfma_f32_16x16x32_bf16 v[140:143], v[72:75], v[92:95], v[140:143]
    ds_read_b64_tr_b16 v[46:47], v14 offset:53248
    s_waitcnt lgkmcnt(12)
    v_mfma_f32_16x16x32_bf16 v[144:147], v[76:79], v[80:83], v[144:147]
    v_mfma_f32_16x16x32_bf16 v[148:151], v[76:79], v[84:87], v[148:151]
    v_mfma_f32_16x16x32_bf16 v[152:155], v[76:79], v[88:91], v[152:155]
    v_mfma_f32_16x16x32_bf16 v[156:159], v[76:79], v[92:95], v[156:159]
    s_waitcnt lgkmcnt(6)
    v_mfma_f32_16x16x32_bf16 v[96:99], v[32:35], v[48:51], v[96:99]
    ds_read_b128 v[80:83], v23 offset:33792
    v_mfma_f32_16x16x32_bf16 v[100:103], v[32:35], v[52:55], v[100:103]
    ds_read_b128 v[84:87], v23 offset:35840
    v_mfma_f32_16x16x32_bf16 v[104:107], v[32:35], v[56:59], v[104:107]
    ds_read_b128 v[88:91], v23 offset:37888
    v_mfma_f32_16x16x32_bf16 v[108:111], v[32:35], v[60:63], v[108:111]
    ds_read_b128 v[92:95], v23 offset:39936
    s_waitcnt lgkmcnt(8)
    v_mfma_f32_16x16x32_bf16 v[112:115], v[36:39], v[48:51], v[112:115]
    ds_read_b64_tr_b16 v[64:65], v11 offset:57344
    v_mfma_f32_16x16x32_bf16 v[116:119], v[36:39], v[52:55], v[116:119]
    ds_read_b64_tr_b16 v[66:67], v11 offset:61440
    v_mfma_f32_16x16x32_bf16 v[120:123], v[36:39], v[56:59], v[120:123]
    ds_read_b64_tr_b16 v[68:69], v12 offset:57344
    v_mfma_f32_16x16x32_bf16 v[124:127], v[36:39], v[60:63], v[124:127]
    ds_read_b64_tr_b16 v[70:71], v12 offset:61440
    s_waitcnt lgkmcnt(10)
    v_mfma_f32_16x16x32_bf16 v[128:131], v[40:43], v[48:51], v[128:131]
    ds_read_b64_tr_b16 v[72:73], v13 offset:57344
    v_mfma_f32_16x16x32_bf16 v[132:135], v[40:43], v[52:55], v[132:135]
    ds_read_b64_tr_b16 v[74:75], v13 offset:61440
    v_mfma_f32_16x16x32_bf16 v[136:139], v[40:43], v[56:59], v[136:139]
    ds_read_b64_tr_b16 v[76:77], v14 offset:57344
    v_mfma_f32_16x16x32_bf16 v[140:143], v[40:43], v[60:63], v[140:143]
    ds_read_b64_tr_b16 v[78:79], v14 offset:61440
    s_waitcnt lgkmcnt(12)
    v_mfma_f32_16x16x32_bf16 v[144:147], v[44:47], v[48:51], v[144:147]
    v_mfma_f32_16x16x32_bf16 v[148:151], v[44:47], v[52:55], v[148:151]
    v_mfma_f32_16x16x32_bf16 v[152:155], v[44:47], v[56:59], v[152:155]
    v_mfma_f32_16x16x32_bf16 v[156:159], v[44:47], v[60:63], v[156:159]
    s_barrier
    s_waitcnt lgkmcnt(6)
    v_mfma_f32_16x16x32_bf16 v[96:99], v[64:67], v[80:83], v[96:99]
    ds_read_b128 v[48:51], v24 offset:0
    v_mfma_f32_16x16x32_bf16 v[100:103], v[64:67], v[84:87], v[100:103]
    ds_read_b128 v[52:55], v24 offset:2048
    v_mfma_f32_16x16x32_bf16 v[104:107], v[64:67], v[88:91], v[104:107]
    ds_read_b128 v[56:59], v24 offset:4096
    v_mfma_f32_16x16x32_bf16 v[108:111], v[64:67], v[92:95], v[108:111]
    ds_read_b128 v[60:63], v24 offset:6144
    s_waitcnt lgkmcnt(8)
    v_mfma_f32_16x16x32_bf16 v[112:115], v[68:71], v[80:83], v[112:115]
    ds_read_b64_tr_b16 v[32:33], v15 offset:16384
    v_mfma_f32_16x16x32_bf16 v[116:119], v[68:71], v[84:87], v[116:119]
    ds_read_b64_tr_b16 v[34:35], v15 offset:20480
    v_mfma_f32_16x16x32_bf16 v[120:123], v[68:71], v[88:91], v[120:123]
    ds_read_b64_tr_b16 v[36:37], v16 offset:16384
    v_mfma_f32_16x16x32_bf16 v[124:127], v[68:71], v[92:95], v[124:127]
    ds_read_b64_tr_b16 v[38:39], v16 offset:20480
    s_waitcnt lgkmcnt(10)
    v_mfma_f32_16x16x32_bf16 v[128:131], v[72:75], v[80:83], v[128:131]
    ds_read_b64_tr_b16 v[40:41], v17 offset:16384
    v_mfma_f32_16x16x32_bf16 v[132:135], v[72:75], v[84:87], v[132:135]
    ds_read_b64_tr_b16 v[42:43], v17 offset:20480
    v_mfma_f32_16x16x32_bf16 v[136:139], v[72:75], v[88:91], v[136:139]
    ds_read_b64_tr_b16 v[44:45], v18 offset:16384
    v_mfma_f32_16x16x32_bf16 v[140:143], v[72:75], v[92:95], v[140:143]
    ds_read_b64_tr_b16 v[46:47], v18 offset:20480
    s_waitcnt lgkmcnt(12)
    v_mfma_f32_16x16x32_bf16 v[144:147], v[76:79], v[80:83], v[144:147]
    v_mfma_f32_16x16x32_bf16 v[148:151], v[76:79], v[84:87], v[148:151]
    v_mfma_f32_16x16x32_bf16 v[152:155], v[76:79], v[88:91], v[152:155]
    v_mfma_f32_16x16x32_bf16 v[156:159], v[76:79], v[92:95], v[156:159]
    s_waitcnt lgkmcnt(6)
    v_mfma_f32_16x16x32_bf16 v[96:99], v[32:35], v[48:51], v[96:99]
    ds_read_b128 v[80:83], v24 offset:1024
    v_mfma_f32_16x16x32_bf16 v[100:103], v[32:35], v[52:55], v[100:103]
    ds_read_b128 v[84:87], v24 offset:3072
    v_mfma_f32_16x16x32_bf16 v[104:107], v[32:35], v[56:59], v[104:107]
    ds_read_b128 v[88:91], v24 offset:5120
    v_mfma_f32_16x16x32_bf16 v[108:111], v[32:35], v[60:63], v[108:111]
    ds_read_b128 v[92:95], v24 offset:7168
    s_waitcnt lgkmcnt(8)
    v_mfma_f32_16x16x32_bf16 v[112:115], v[36:39], v[48:51], v[112:115]
    ds_read_b64_tr_b16 v[64:65], v15 offset:24576
    v_mfma_f32_16x16x32_bf16 v[116:119], v[36:39], v[52:55], v[116:119]
    ds_read_b64_tr_b16 v[66:67], v15 offset:28672
    v_mfma_f32_16x16x32_bf16 v[120:123], v[36:39], v[56:59], v[120:123]
    ds_read_b64_tr_b16 v[68:69], v16 offset:24576
    v_mfma_f32_16x16x32_bf16 v[124:127], v[36:39], v[60:63], v[124:127]
    ds_read_b64_tr_b16 v[70:71], v16 offset:28672
    s_waitcnt lgkmcnt(10)
    v_mfma_f32_16x16x32_bf16 v[128:131], v[40:43], v[48:51], v[128:131]
    ds_read_b64_tr_b16 v[72:73], v17 offset:24576
    v_mfma_f32_16x16x32_bf16 v[132:135], v[40:43], v[52:55], v[132:135]
    ds_read_b64_tr_b16 v[74:75], v17 offset:28672
    v_mfma_f32_16x16x32_bf16 v[136:139], v[40:43], v[56:59], v[136:139]
    ds_read_b64_tr_b16 v[76:77], v18 offset:24576
    v_mfma_f32_16x16x32_bf16 v[140:143], v[40:43], v[60:63], v[140:143]
    ds_read_b64_tr_b16 v[78:79], v18 offset:28672
    s_waitcnt lgkmcnt(12)
    v_mfma_f32_16x16x32_bf16 v[144:147], v[44:47], v[48:51], v[144:147]
    v_mfma_f32_16x16x32_bf16 v[148:151], v[44:47], v[52:55], v[148:151]
    v_mfma_f32_16x16x32_bf16 v[152:155], v[44:47], v[56:59], v[152:155]
    v_mfma_f32_16x16x32_bf16 v[156:159], v[44:47], v[60:63], v[156:159]
    s_barrier
    s_waitcnt lgkmcnt(6)
    v_mfma_f32_16x16x32_bf16 v[96:99], v[64:67], v[80:83], v[96:99]
    ds_read_b128 v[48:51], v24 offset:32768
    v_mfma_f32_16x16x32_bf16 v[100:103], v[64:67], v[84:87], v[100:103]
    ds_read_b128 v[52:55], v24 offset:34816
    v_mfma_f32_16x16x32_bf16 v[104:107], v[64:67], v[88:91], v[104:107]
    ds_read_b128 v[56:59], v24 offset:36864
    v_mfma_f32_16x16x32_bf16 v[108:111], v[64:67], v[92:95], v[108:111]
    ds_read_b128 v[60:63], v24 offset:38912
    s_waitcnt lgkmcnt(8)
    v_mfma_f32_16x16x32_bf16 v[112:115], v[68:71], v[80:83], v[112:115]
    ds_read_b64_tr_b16 v[32:33], v15 offset:49152
    v_mfma_f32_16x16x32_bf16 v[116:119], v[68:71], v[84:87], v[116:119]
    ds_read_b64_tr_b16 v[34:35], v15 offset:53248
    v_mfma_f32_16x16x32_bf16 v[120:123], v[68:71], v[88:91], v[120:123]
    ds_read_b64_tr_b16 v[36:37], v16 offset:49152
    v_mfma_f32_16x16x32_bf16 v[124:127], v[68:71], v[92:95], v[124:127]
    ds_read_b64_tr_b16 v[38:39], v16 offset:53248
    s_waitcnt lgkmcnt(10)
    v_mfma_f32_16x16x32_bf16 v[128:131], v[72:75], v[80:83], v[128:131]
    ds_read_b64_tr_b16 v[40:41], v17 offset:49152
    v_mfma_f32_16x16x32_bf16 v[132:135], v[72:75], v[84:87], v[132:135]
    ds_read_b64_tr_b16 v[42:43], v17 offset:53248
    v_mfma_f32_16x16x32_bf16 v[136:139], v[72:75], v[88:91], v[136:139]
    ds_read_b64_tr_b16 v[44:45], v18 offset:49152
    v_mfma_f32_16x16x32_bf16 v[140:143], v[72:75], v[92:95], v[140:143]
    ds_read_b64_tr_b16 v[46:47], v18 offset:53248
    s_waitcnt lgkmcnt(12)
    v_mfma_f32_16x16x32_bf16 v[144:147], v[76:79], v[80:83], v[144:147]
    v_mfma_f32_16x16x32_bf16 v[148:151], v[76:79], v[84:87], v[148:151]
    v_mfma_f32_16x16x32_bf16 v[152:155], v[76:79], v[88:91], v[152:155]
    v_mfma_f32_16x16x32_bf16 v[156:159], v[76:79], v[92:95], v[156:159]
    s_waitcnt lgkmcnt(6)
    v_mfma_f32_16x16x32_bf16 v[96:99], v[32:35], v[48:51], v[96:99]
    ds_read_b128 v[80:83], v24 offset:33792
    v_mfma_f32_16x16x32_bf16 v[100:103], v[32:35], v[52:55], v[100:103]
    ds_read_b128 v[84:87], v24 offset:35840
    v_mfma_f32_16x16x32_bf16 v[104:107], v[32:35], v[56:59], v[104:107]
    ds_read_b128 v[88:91], v24 offset:37888
    v_mfma_f32_16x16x32_bf16 v[108:111], v[32:35], v[60:63], v[108:111]
    ds_read_b128 v[92:95], v24 offset:39936
    s_waitcnt lgkmcnt(8)
    v_mfma_f32_16x16x32_bf16 v[112:115], v[36:39], v[48:51], v[112:115]
    ds_read_b64_tr_b16 v[64:65], v15 offset:57344
    v_mfma_f32_16x16x32_bf16 v[116:119], v[36:39], v[52:55], v[116:119]
    ds_read_b64_tr_b16 v[66:67], v15 offset:61440
    v_mfma_f32_16x16x32_bf16 v[120:123], v[36:39], v[56:59], v[120:123]
    ds_read_b64_tr_b16 v[68:69], v16 offset:57344
    v_mfma_f32_16x16x32_bf16 v[124:127], v[36:39], v[60:63], v[124:127]
    ds_read_b64_tr_b16 v[70:71], v16 offset:61440
    s_waitcnt lgkmcnt(10)
    v_mfma_f32_16x16x32_bf16 v[128:131], v[40:43], v[48:51], v[128:131]
    ds_read_b64_tr_b16 v[72:73], v17 offset:57344
    v_mfma_f32_16x16x32_bf16 v[132:135], v[40:43], v[52:55], v[132:135]
    ds_read_b64_tr_b16 v[74:75], v17 offset:61440
    v_mfma_f32_16x16x32_bf16 v[136:139], v[40:43], v[56:59], v[136:139]
    ds_read_b64_tr_b16 v[76:77], v18 offset:57344
    v_mfma_f32_16x16x32_bf16 v[140:143], v[40:43], v[60:63], v[140:143]
    ds_read_b64_tr_b16 v[78:79], v18 offset:61440
    s_waitcnt lgkmcnt(12)
    v_mfma_f32_16x16x32_bf16 v[144:147], v[44:47], v[48:51], v[144:147]
    v_mfma_f32_16x16x32_bf16 v[148:151], v[44:47], v[52:55], v[148:151]
    v_mfma_f32_16x16x32_bf16 v[152:155], v[44:47], v[56:59], v[152:155]
    v_mfma_f32_16x16x32_bf16 v[156:159], v[44:47], v[60:63], v[156:159]
    s_barrier
    s_waitcnt lgkmcnt(6)
    v_mfma_f32_16x16x32_bf16 v[96:99], v[64:67], v[80:83], v[96:99]
    ds_read_b128 v[48:51], v25 offset:0
    v_mfma_f32_16x16x32_bf16 v[100:103], v[64:67], v[84:87], v[100:103]
    ds_read_b128 v[52:55], v25 offset:2048
    v_mfma_f32_16x16x32_bf16 v[104:107], v[64:67], v[88:91], v[104:107]
    ds_read_b128 v[56:59], v25 offset:4096
    v_mfma_f32_16x16x32_bf16 v[108:111], v[64:67], v[92:95], v[108:111]
    ds_read_b128 v[60:63], v25 offset:6144
    s_waitcnt lgkmcnt(8)
    v_mfma_f32_16x16x32_bf16 v[112:115], v[68:71], v[80:83], v[112:115]
    ds_read_b64_tr_b16 v[32:33], v19 offset:16384
    v_mfma_f32_16x16x32_bf16 v[116:119], v[68:71], v[84:87], v[116:119]
    ds_read_b64_tr_b16 v[34:35], v19 offset:20480
    v_mfma_f32_16x16x32_bf16 v[120:123], v[68:71], v[88:91], v[120:123]
    ds_read_b64_tr_b16 v[36:37], v20 offset:16384
    v_mfma_f32_16x16x32_bf16 v[124:127], v[68:71], v[92:95], v[124:127]
    ds_read_b64_tr_b16 v[38:39], v20 offset:20480
    s_waitcnt lgkmcnt(10)
    v_mfma_f32_16x16x32_bf16 v[128:131], v[72:75], v[80:83], v[128:131]
    ds_read_b64_tr_b16 v[40:41], v21 offset:16384
    v_mfma_f32_16x16x32_bf16 v[132:135], v[72:75], v[84:87], v[132:135]
    ds_read_b64_tr_b16 v[42:43], v21 offset:20480
    v_mfma_f32_16x16x32_bf16 v[136:139], v[72:75], v[88:91], v[136:139]
    ds_read_b64_tr_b16 v[44:45], v22 offset:16384
    v_mfma_f32_16x16x32_bf16 v[140:143], v[72:75], v[92:95], v[140:143]
    ds_read_b64_tr_b16 v[46:47], v22 offset:20480
    s_waitcnt lgkmcnt(12)
    v_mfma_f32_16x16x32_bf16 v[144:147], v[76:79], v[80:83], v[144:147]
    v_mfma_f32_16x16x32_bf16 v[148:151], v[76:79], v[84:87], v[148:151]
    v_mfma_f32_16x16x32_bf16 v[152:155], v[76:79], v[88:91], v[152:155]
    v_mfma_f32_16x16x32_bf16 v[156:159], v[76:79], v[92:95], v[156:159]
    s_waitcnt lgkmcnt(6)
    v_mfma_f32_16x16x32_bf16 v[96:99], v[32:35], v[48:51], v[96:99]
    ds_read_b128 v[80:83], v25 offset:1024
    v_mfma_f32_16x16x32_bf16 v[100:103], v[32:35], v[52:55], v[100:103]
    ds_read_b128 v[84:87], v25 offset:3072
    v_mfma_f32_16x16x32_bf16 v[104:107], v[32:35], v[56:59], v[104:107]
    ds_read_b128 v[88:91], v25 offset:5120
    v_mfma_f32_16x16x32_bf16 v[108:111], v[32:35], v[60:63], v[108:111]
    ds_read_b128 v[92:95], v25 offset:7168
    s_waitcnt lgkmcnt(8)
    v_mfma_f32_16x16x32_bf16 v[112:115], v[36:39], v[48:51], v[112:115]
    ds_read_b64_tr_b16 v[64:65], v19 offset:24576
    v_mfma_f32_16x16x32_bf16 v[116:119], v[36:39], v[52:55], v[116:119]
    ds_read_b64_tr_b16 v[66:67], v19 offset:28672
    v_mfma_f32_16x16x32_bf16 v[120:123], v[36:39], v[56:59], v[120:123]
    ds_read_b64_tr_b16 v[68:69], v20 offset:24576
    v_mfma_f32_16x16x32_bf16 v[124:127], v[36:39], v[60:63], v[124:127]
    ds_read_b64_tr_b16 v[70:71], v20 offset:28672
    s_waitcnt lgkmcnt(10)
    v_mfma_f32_16x16x32_bf16 v[128:131], v[40:43], v[48:51], v[128:131]
    ds_read_b64_tr_b16 v[72:73], v21 offset:24576
    v_mfma_f32_16x16x32_bf16 v[132:135], v[40:43], v[52:55], v[132:135]
    ds_read_b64_tr_b16 v[74:75], v21 offset:28672
    v_mfma_f32_16x16x32_bf16 v[136:139], v[40:43], v[56:59], v[136:139]
    ds_read_b64_tr_b16 v[76:77], v22 offset:24576
    v_mfma_f32_16x16x32_bf16 v[140:143], v[40:43], v[60:63], v[140:143]
    ds_read_b64_tr_b16 v[78:79], v22 offset:28672
    s_waitcnt lgkmcnt(12)
    v_mfma_f32_16x16x32_bf16 v[144:147], v[44:47], v[48:51], v[144:147]
    v_mfma_f32_16x16x32_bf16 v[148:151], v[44:47], v[52:55], v[148:151]
    v_mfma_f32_16x16x32_bf16 v[152:155], v[44:47], v[56:59], v[152:155]
    v_mfma_f32_16x16x32_bf16 v[156:159], v[44:47], v[60:63], v[156:159]
    s_barrier
    s_waitcnt lgkmcnt(6)
    v_mfma_f32_16x16x32_bf16 v[96:99], v[64:67], v[80:83], v[96:99]
    ds_read_b128 v[48:51], v23 offset:0
    v_mfma_f32_16x16x32_bf16 v[100:103], v[64:67], v[84:87], v[100:103]
    ds_read_b128 v[52:55], v23 offset:2048
    v_mfma_f32_16x16x32_bf16 v[104:107], v[64:67], v[88:91], v[104:107]
    ds_read_b128 v[56:59], v23 offset:4096
    v_mfma_f32_16x16x32_bf16 v[108:111], v[64:67], v[92:95], v[108:111]
    ds_read_b128 v[60:63], v23 offset:6144
    s_waitcnt lgkmcnt(8)
    v_mfma_f32_16x16x32_bf16 v[112:115], v[68:71], v[80:83], v[112:115]
    ds_read_b64_tr_b16 v[32:33], v11 offset:16384
    v_mfma_f32_16x16x32_bf16 v[116:119], v[68:71], v[84:87], v[116:119]
    ds_read_b64_tr_b16 v[34:35], v11 offset:20480
    v_mfma_f32_16x16x32_bf16 v[120:123], v[68:71], v[88:91], v[120:123]
    ds_read_b64_tr_b16 v[36:37], v12 offset:16384
    v_mfma_f32_16x16x32_bf16 v[124:127], v[68:71], v[92:95], v[124:127]
    ds_read_b64_tr_b16 v[38:39], v12 offset:20480
    s_waitcnt lgkmcnt(10)
    v_mfma_f32_16x16x32_bf16 v[128:131], v[72:75], v[80:83], v[128:131]
    ds_read_b64_tr_b16 v[40:41], v13 offset:16384
    v_mfma_f32_16x16x32_bf16 v[132:135], v[72:75], v[84:87], v[132:135]
    ds_read_b64_tr_b16 v[42:43], v13 offset:20480
    v_mfma_f32_16x16x32_bf16 v[136:139], v[72:75], v[88:91], v[136:139]
    ds_read_b64_tr_b16 v[44:45], v14 offset:16384
    v_mfma_f32_16x16x32_bf16 v[140:143], v[72:75], v[92:95], v[140:143]
    ds_read_b64_tr_b16 v[46:47], v14 offset:20480
    s_waitcnt lgkmcnt(12)
    v_mfma_f32_16x16x32_bf16 v[144:147], v[76:79], v[80:83], v[144:147]
    v_mfma_f32_16x16x32_bf16 v[148:151], v[76:79], v[84:87], v[148:151]
    v_mfma_f32_16x16x32_bf16 v[152:155], v[76:79], v[88:91], v[152:155]
    v_mfma_f32_16x16x32_bf16 v[156:159], v[76:79], v[92:95], v[156:159]
    s_waitcnt lgkmcnt(6)
    v_mfma_f32_16x16x32_bf16 v[96:99], v[32:35], v[48:51], v[96:99]
    ds_read_b128 v[80:83], v23 offset:1024
    v_mfma_f32_16x16x32_bf16 v[100:103], v[32:35], v[52:55], v[100:103]
    ds_read_b128 v[84:87], v23 offset:3072
    v_mfma_f32_16x16x32_bf16 v[104:107], v[32:35], v[56:59], v[104:107]
    ds_read_b128 v[88:91], v23 offset:5120
    v_mfma_f32_16x16x32_bf16 v[108:111], v[32:35], v[60:63], v[108:111]
    ds_read_b128 v[92:95], v23 offset:7168
    s_waitcnt lgkmcnt(8)
    v_mfma_f32_16x16x32_bf16 v[112:115], v[36:39], v[48:51], v[112:115]
    ds_read_b64_tr_b16 v[64:65], v11 offset:24576
    v_mfma_f32_16x16x32_bf16 v[116:119], v[36:39], v[52:55], v[116:119]
    ds_read_b64_tr_b16 v[66:67], v11 offset:28672
    v_mfma_f32_16x16x32_bf16 v[120:123], v[36:39], v[56:59], v[120:123]
    ds_read_b64_tr_b16 v[68:69], v12 offset:24576
    v_mfma_f32_16x16x32_bf16 v[124:127], v[36:39], v[60:63], v[124:127]
    ds_read_b64_tr_b16 v[70:71], v12 offset:28672
    s_waitcnt lgkmcnt(10)
    v_mfma_f32_16x16x32_bf16 v[128:131], v[40:43], v[48:51], v[128:131]
    ds_read_b64_tr_b16 v[72:73], v13 offset:24576
    v_mfma_f32_16x16x32_bf16 v[132:135], v[40:43], v[52:55], v[132:135]
    ds_read_b64_tr_b16 v[74:75], v13 offset:28672
    v_mfma_f32_16x16x32_bf16 v[136:139], v[40:43], v[56:59], v[136:139]
    ds_read_b64_tr_b16 v[76:77], v14 offset:24576
    v_mfma_f32_16x16x32_bf16 v[140:143], v[40:43], v[60:63], v[140:143]
    ds_read_b64_tr_b16 v[78:79], v14 offset:28672
    s_waitcnt lgkmcnt(12)
    v_mfma_f32_16x16x32_bf16 v[144:147], v[44:47], v[48:51], v[144:147]
    v_mfma_f32_16x16x32_bf16 v[148:151], v[44:47], v[52:55], v[148:151]
    v_mfma_f32_16x16x32_bf16 v[152:155], v[44:47], v[56:59], v[152:155]
    v_mfma_f32_16x16x32_bf16 v[156:159], v[44:47], v[60:63], v[156:159]
    s_waitcnt lgkmcnt(6)
    v_mfma_f32_16x16x32_bf16 v[96:99], v[64:67], v[80:83], v[96:99]
    v_mfma_f32_16x16x32_bf16 v[100:103], v[64:67], v[84:87], v[100:103]
    v_mfma_f32_16x16x32_bf16 v[104:107], v[64:67], v[88:91], v[104:107]
    v_mfma_f32_16x16x32_bf16 v[108:111], v[64:67], v[92:95], v[108:111]
    s_waitcnt lgkmcnt(4)
    v_mfma_f32_16x16x32_bf16 v[112:115], v[68:71], v[80:83], v[112:115]
    v_mfma_f32_16x16x32_bf16 v[116:119], v[68:71], v[84:87], v[116:119]
    v_mfma_f32_16x16x32_bf16 v[120:123], v[68:71], v[88:91], v[120:123]
    v_mfma_f32_16x16x32_bf16 v[124:127], v[68:71], v[92:95], v[124:127]
    s_waitcnt lgkmcnt(2)
    v_mfma_f32_16x16x32_bf16 v[128:131], v[72:75], v[80:83], v[128:131]
    v_mfma_f32_16x16x32_bf16 v[132:135], v[72:75], v[84:87], v[132:135]
    v_mfma_f32_16x16x32_bf16 v[136:139], v[72:75], v[88:91], v[136:139]
    v_mfma_f32_16x16x32_bf16 v[140:143], v[72:75], v[92:95], v[140:143]
    s_waitcnt lgkmcnt(0)
    v_mfma_f32_16x16x32_bf16 v[144:147], v[76:79], v[80:83], v[144:147]
    v_mfma_f32_16x16x32_bf16 v[148:151], v[76:79], v[84:87], v[148:151]
    v_mfma_f32_16x16x32_bf16 v[152:155], v[76:79], v[88:91], v[152:155]
    v_mfma_f32_16x16x32_bf16 v[156:159], v[76:79], v[92:95], v[156:159]
    s_nop 15
    s_cmp_eq_u32 s7, 0
    s_cbranch_scc1 L_skipq0
    s_add_u32 s30, s28, 0
    v_cvt_pk_bf16_f32 v96, v96, v97
    v_cvt_pk_bf16_f32 v97, v98, v99
    v_cvt_pk_bf16_f32 v98, v100, v101
    v_cvt_pk_bf16_f32 v99, v102, v103
    buffer_store_dwordx4 v[96:99], v10, s[56:59], s30 offen offset:0 sc1
    v_cvt_pk_bf16_f32 v104, v104, v105
    v_cvt_pk_bf16_f32 v105, v106, v107
    v_cvt_pk_bf16_f32 v106, v108, v109
    v_cvt_pk_bf16_f32 v107, v110, v111
    buffer_store_dwordx4 v[104:107], v10, s[56:59], s30 offen offset:1024 sc1
    s_branch L_nown0
L_skipq0:
    v_mov_b32 v32, v96
    v_mov_b32 v33, v97
    v_mov_b32 v34, v98
    v_mov_b32 v35, v99
    v_mov_b32 v36, v100
    v_mov_b32 v37, v101
    v_mov_b32 v38, v102
    v_mov_b32 v39, v103
    v_mov_b32 v40, v104
    v_mov_b32 v41, v105
    v_mov_b32 v42, v106
    v_mov_b32 v43, v107
    v_mov_b32 v44, v108
    v_mov_b32 v45, v109
    v_mov_b32 v46, v110
    v_mov_b32 v47, v111
L_nown0:
    s_cmp_eq_u32 s7, 1
    s_cbranch_scc1 L_skipq1
    s_add_u32 s30, s28, 4096
    v_cvt_pk_bf16_f32 v112, v112, v113
    v_cvt_pk_bf16_f32 v113, v114, v115
    v_cvt_pk_bf16_f32 v114, v116, v117
    v_cvt_pk_bf16_f32 v115, v118, v119
    buffer_store_dwordx4 v[112:115], v10, s[56:59], s30 offen offset:0 sc1
    v_cvt_pk_bf16_f32 v120, v120, v121
    v_cvt_pk_bf16_f32 v121, v122, v123
    v_cvt_pk_bf16_f32 v122, v124, v125
    v_cvt_pk_bf16_f32 v123, v126, v127
    buffer_store_dwordx4 v[120:123], v10, s[56:59], s30 offen offset:1024 sc1
    s_branch L_nown1
L_skipq1:
    v_mov_b32 v32, v112
    v_mov_b32 v33, v113
    v_mov_b32 v34, v114
    v_mov_b32 v35, v115
    v_mov_b32 v36, v116
    v_mov_b32 v37, v117
    v_mov_b32 v38, v118
    v_mov_b32 v39, v119
    v_mov_b32 v40, v120
    v_mov_b32 v41, v121
    v_mov_b32 v42, v122
    v_mov_b32 v43, v123
    v_mov_b32 v44, v124
    v_mov_b32 v45, v125
    v_mov_b32 v46, v126
    v_mov_b32 v47, v127
L_nown1:
    s_cmp_eq_u32 s7, 2
    s_cbranch_scc1 L_skipq2
    s_add_u32 s30, s28, 8192
    v_cvt_pk_bf16_f32 v128, v128, v129
    v_cvt_pk_bf16_f32 v129, v130, v131
    v_cvt_pk_bf16_f32 v130, v132, v133
    v_cvt_pk_bf16_f32 v131, v134, v135
    buffer_store_dwordx4 v[128:131], v10, s[56:59], s30 offen offset:0 sc1
    v_cvt_pk_bf16_f32 v136, v136, v137
    v_cvt_pk_bf16_f32 v137, v138, v139
    v_cvt_pk_bf16_f32 v138, v140, v141
    v_cvt_pk_bf16_f32 v139, v142, v143
    buffer_store_dwordx4 v[136:139], v10, s[56:59], s30 offen offset:1024 sc1
    s_branch L_nown2
L_skipq2:
    v_mov_b32 v32, v128
    v_mov_b32 v33, v129
    v_mov_b32 v34, v130
    v_mov_b32 v35, v131
    v_mov_b32 v36, v132
    v_mov_b32 v37, v133
    v_mov_b32 v38, v134
    v_mov_b32 v39, v135
    v_mov_b32 v40, v136
    v_mov_b32 v41, v137
    v_mov_b32 v42, v138
    v_mov_b32 v43, v139
    v_mov_b32 v44, v140
    v_mov_b32 v45, v141
    v_mov_b32 v46, v142
    v_mov_b32 v47, v143
L_nown2:
    s_cmp_eq_u32 s7, 3
    s_cbranch_scc1 L_skipq3
    s_add_u32 s30, s28, 12288
    v_cvt_pk_bf16_f32 v144, v144, v145
    v_cvt_pk_bf16_f32 v145, v146, v147
    v_cvt_pk_bf16_f32 v146, v148, v149
    v_cvt_pk_bf16_f32 v147, v150, v151
    buffer_store_dwordx4 v[144:147], v10, s[56:59], s30 offen offset:0 sc1
    v_cvt_pk_bf16_f32 v152, v152, v153
    v_cvt_pk_bf16_f32 v153, v154, v155
    v_cvt_pk_bf16_f32 v154, v156, v157
    v_cvt_pk_bf16_f32 v155, v158, v159
    buffer_store_dwordx4 v[152:155], v10, s[56:59], s30 offen offset:1024 sc1
    s_branch L_nown3
L_skipq3:
    v_mov_b32 v32, v144
    v_mov_b32 v33, v145
    v_mov_b32 v34, v146
    v_mov_b32 v35, v147
    v_mov_b32 v36, v148
    v_mov_b32 v37, v149
    v_mov_b32 v38, v150
    v_mov_b32 v39, v151
    v_mov_b32 v40, v152
    v_mov_b32 v41, v153
    v_mov_b32 v42, v154
    v_mov_b32 v43, v155
    v_mov_b32 v44, v156
    v_mov_b32 v45, v157
    v_mov_b32 v46, v158
    v_mov_b32 v47, v159
L_nown3:
    s_waitcnt vmcnt(0)
    s_barrier
    s_barrier
    s_lshl_b32 s31, s7, 12
    s_add_u32 s31, s31, s27
    s_add_u32 s30, s7, 1
    s_and_b32 s30, s30, 3
    s_lshl_b32 s30, s30, 16
    s_add_u32 s30, s30, s31
    buffer_load_dwordx4 v[160:163], v10, s[56:59], s30 offen offset:0 sc1
    buffer_load_dwordx4 v[164:167], v10, s[56:59], s30 offen offset:1024 sc1
    s_add_u32 s30, s7, 2
    s_and_b32 s30, s30, 3
    s_lshl_b32 s30, s30, 16
    s_add_u32 s30, s30, s31
    buffer_load_dwordx4 v[176:179], v10, s[56:59], s30 offen offset:0 sc1
    buffer_load_dwordx4 v[180:183], v10, s[56:59], s30 offen offset:1024 sc1
    s_add_u32 s30, s7, 3
    s_and_b32 s30, s30, 3
    s_lshl_b32 s30, s30, 16
    s_add_u32 s30, s30, s31
    buffer_load_dwordx4 v[192:195], v10, s[56:59], s30 offen offset:0 sc1
    buffer_load_dwordx4 v[196:199], v10, s[56:59], s30 offen offset:1024 sc1
    s_mov_b32 s13, 0xffff0000
    s_waitcnt vmcnt(5)
    v_lshlrev_b32 v96, 16, v160
    v_and_b32 v97, s13, v160
    v_add_f32 v32, v32, v96
    v_add_f32 v33, v33, v97
    v_lshlrev_b32 v96, 16, v161
    v_and_b32 v97, s13, v161
    v_add_f32 v34, v34, v96
    v_add_f32 v35, v35, v97
    s_waitcnt vmcnt(3)
    v_lshlrev_b32 v96, 16, v176
    v_and_b32 v97, s13, v176
    v_add_f32 v32, v32, v96
    v_add_f32 v33, v33, v97
    v_lshlrev_b32 v96, 16, v177
    v_and_b32 v97, s13, v177
    v_add_f32 v34, v34, v96
    v_add_f32 v35, v35, v97
    s_waitcnt vmcnt(1)
    v_lshlrev_b32 v96, 16, v192
    v_and_b32 v97, s13, v192
    v_add_f32 v32, v32, v96
    v_add_f32 v33, v33, v97
    v_lshlrev_b32 v96, 16, v193
    v_and_b32 v97, s13, v193
    v_add_f32 v34, v34, v96
    v_add_f32 v35, v35, v97
    v_cvt_pk_bf16_f32 v100, v32, v33
    v_cvt_pk_bf16_f32 v101, v34, v35
    s_add_u32 s30, s29, 0
    buffer_store_dwordx2 v[100:101], v26, s[64:67], s30 offen
    v_lshlrev_b32 v96, 16, v162
    v_and_b32 v97, s13, v162
    v_add_f32 v36, v36, v96
    v_add_f32 v37, v37, v97
    v_lshlrev_b32 v96, 16, v163
    v_and_b32 v97, s13, v163
    v_add_f32 v38, v38, v96
    v_add_f32 v39, v39, v97
    v_lshlrev_b32 v96, 16, v178
    v_and_b32 v97, s13, v178
    v_add_f32 v36, v36, v96
    v_add_f32 v37, v37, v97
    v_lshlrev_b32 v96, 16, v179
    v_and_b32 v97, s13, v179
    v_add_f32 v38, v38, v96
    v_add_f32 v39, v39, v97
    v_lshlrev_b32 v96, 16, v194
    v_and_b32 v97, s13, v194
    v_add_f32 v36, v36, v96
    v_add_f32 v37, v37, v97
    v_lshlrev_b32 v96, 16, v195
    v_and_b32 v97, s13, v195
    v_add_f32 v38, v38, v96
    v_add_f32 v39, v39, v97
    v_cvt_pk_bf16_f32 v102, v36, v37
    v_cvt_pk_bf16_f32 v103, v38, v39
    s_add_u32 s30, s29, 40960
    buffer_store_dwordx2 v[102:103], v26, s[64:67], s30 offen
    v_lshlrev_b32 v96, 16, v164
    v_and_b32 v97, s13, v164
    v_add_f32 v40, v40, v96
    v_add_f32 v41, v41, v97
    v_lshlrev_b32 v96, 16, v165
    v_and_b32 v97, s13, v165
    v_add_f32 v42, v42, v96
    v_add_f32 v43, v43, v97
    v_lshlrev_b32 v96, 16, v180
    v_and_b32 v97, s13, v180
    v_add_f32 v40, v40, v96
    v_add_f32 v41, v41, v97
    v_lshlrev_b32 v96, 16, v181
    v_and_b32 v97, s13, v181
    v_add_f32 v42, v42, v96
    v_add_f32 v43, v43, v97
    s_waitcnt vmcnt(2)
    v_lshlrev_b32 v96, 16, v196
    v_and_b32 v97, s13, v196
    v_add_f32 v40, v40, v96
    v_add_f32 v41, v41, v97
    v_lshlrev_b32 v96, 16, v197
    v_and_b32 v97, s13, v197
    v_add_f32 v42, v42, v96
    v_add_f32 v43, v43, v97
    v_cvt_pk_bf16_f32 v104, v40, v41
    v_cvt_pk_bf16_f32 v105, v42, v43
    s_add_u32 s30, s29, 81920
    buffer_store_dwordx2 v[104:105], v26, s[64:67], s30 offen
    v_lshlrev_b32 v96, 16, v166
    v_and_b32 v97, s13, v166
    v_add_f32 v44, v44, v96
    v_add_f32 v45, v45, v97
    v_lshlrev_b32 v96, 16, v167
    v_and_b32 v97, s13, v167
    v_add_f32 v46, v46, v96
    v_add_f32 v47, v47, v97
    v_lshlrev_b32 v96, 16, v182
    v_and_b32 v97, s13, v182
    v_add_f32 v44, v44, v96
    v_add_f32 v45, v45, v97
    v_lshlrev_b32 v96, 16, v183
    v_and_b32 v97, s13, v183
    v_add_f32 v46, v46, v96
    v_add_f32 v47, v47, v97
    v_lshlrev_b32 v96, 16, v198
    v_and_b32 v97, s13, v198
    v_add_f32 v44, v44, v96
    v_add_f32 v45, v45, v97
    v_lshlrev_b32 v96, 16, v199
    v_and_b32 v97, s13, v199
    v_add_f32 v46, v46, v96
    v_add_f32 v47, v47, v97
    v_cvt_pk_bf16_f32 v106, v44, v45
    v_cvt_pk_bf16_f32 v107, v46, v47
    s_add_u32 s30, s29, 122880
    buffer_store_dwordx2 v[106:107], v26, s[64:67], s30 offen
    s_endpgm
L_loader_k2:
    s_mul_i32 s13, s6, 48
    s_lshl_b32 s12, s17, 3
    s_add_u32 s13, s13, s12
    s_lshl_b32 s12, s3, 1
    s_add_u32 s13, s13, s12
    s_lshl_b32 s13, s13, 7
    s_lshl_b32 s12, s7, 5
    s_add_u32 s13, s13, s12
    s_lshl_b32 s24, s13, 10
    s_lshl_b32 s25, s3, 12
    s_mul_i32 s72, s18, 1
    s_add_u32 s73, s72, 0
    s_and_b32 s73, s73, 15
    s_lshl_b32 s73, s73, 11
    s_add_u32 s73, s73, s24
    s_add_u32 m0, s25, 0
    s_add_u32 s97, s73, 0
    buffer_load_dwordx4 v10, s[56:59], s97 offen lds
    s_add_u32 m0, s25, 1024
    s_add_u32 s97, s73, 1024
    buffer_load_dwordx4 v10, s[56:59], s97 offen lds
    s_add_u32 m0, s25, 2048
    s_add_u32 s97, s73, 131072
    buffer_load_dwordx4 v10, s[56:59], s97 offen lds
    s_add_u32 m0, s25, 3072
    s_add_u32 s97, s73, 132096
    buffer_load_dwordx4 v10, s[56:59], s97 offen lds
    v_lshlrev_b32 v7, 1, v2
    v_xor_b32 v7, v7, v3
    v_lshlrev_b32 v7, 4, v7
    v_mul_u32_u24 v8, 1280, v2
    v_add_u32 v11, v7, v8
    v_xor_b32 v7, 0x80, v7
    v_add_u32 v12, v7, v8
    s_lshl_b32 s13, s7, 10
    s_lshl_b32 s12, s3, 4
    s_add_u32 s13, s13, s12
    s_mul_i32 s13, s13, 1280
    s_lshl_b32 s12, s18, 8
    s_add_u32 s26, s13, s12
    s_lshl_b32 s27, s3, 12
    s_add_u32 s27, s27, 16384
    s_add_u32 s74, s72, 0
    s_and_b32 s74, s74, 15
    s_mul_i32 s74, s74, 81920
    s_add_u32 s74, s74, s26
    s_add_u32 m0, s27, 0
    s_add_u32 s97, s74, 0
    buffer_load_dwordx4 v11, s[60:63], s97 offen lds
    s_add_u32 m0, s27, 1024
    s_add_u32 s97, s74, 5120
    buffer_load_dwordx4 v12, s[60:63], s97 offen lds
    s_add_u32 m0, s27, 2048
    s_add_u32 s97, s74, 10240
    buffer_load_dwordx4 v11, s[60:63], s97 offen lds
    s_add_u32 m0, s27, 3072
    s_add_u32 s97, s74, 15360
    buffer_load_dwordx4 v12, s[60:63], s97 offen lds
    s_add_u32 s73, s72, 1
    s_and_b32 s73, s73, 15
    s_lshl_b32 s73, s73, 11
    s_add_u32 s73, s73, s24
    s_add_u32 m0, s25, 32768
    s_add_u32 s97, s73, 0
    buffer_load_dwordx4 v10, s[56:59], s97 offen lds
    s_add_u32 m0, s25, 33792
    s_add_u32 s97, s73, 1024
    buffer_load_dwordx4 v10, s[56:59], s97 offen lds
    s_add_u32 m0, s25, 34816
    s_add_u32 s97, s73, 131072
    buffer_load_dwordx4 v10, s[56:59], s97 offen lds
    s_add_u32 m0, s25, 35840
    s_add_u32 s97, s73, 132096
    buffer_load_dwordx4 v10, s[56:59], s97 offen lds
    s_add_u32 s74, s72, 1
    s_and_b32 s74, s74, 15
    s_mul_i32 s74, s74, 81920
    s_add_u32 s74, s74, s26
    s_add_u32 m0, s27, 32768
    s_add_u32 s97, s74, 0
    buffer_load_dwordx4 v11, s[60:63], s97 offen lds
    s_add_u32 m0, s27, 33792
    s_add_u32 s97, s74, 5120
    buffer_load_dwordx4 v12, s[60:63], s97 offen lds
    s_add_u32 m0, s27, 34816
    s_add_u32 s97, s74, 10240
    buffer_load_dwordx4 v11, s[60:63], s97 offen lds
    s_add_u32 m0, s27, 35840
    s_add_u32 s97, s74, 15360
    buffer_load_dwordx4 v12, s[60:63], s97 offen lds
    s_lshl_b32 s10, s2, 7
    s_add_u32 s10, s10, 50331648
    v_mov_b32 v16, s10
    s_and_b32 s10, s2, 0xfc
    s_lshl_b32 s10, s10, 7
    s_add_u32 s10, s10, 50331648
    v_and_b32 v7, 3, v1
    v_lshlrev_b32 v7, 7, v7
    v_add_u32 v17, s10, v7
    s_waitcnt vmcnt(8)
    s_barrier
    s_add_u32 s73, s72, 2
    s_and_b32 s73, s73, 15
    s_lshl_b32 s73, s73, 11
    s_add_u32 s73, s73, s24
    s_add_u32 m0, s25, 65536
    s_add_u32 s97, s73, 0
    buffer_load_dwordx4 v10, s[56:59], s97 offen lds
    s_add_u32 m0, s25, 66560
    s_add_u32 s97, s73, 1024
    buffer_load_dwordx4 v10, s[56:59], s97 offen lds
    s_add_u32 m0, s25, 67584
    s_add_u32 s97, s73, 131072
    buffer_load_dwordx4 v10, s[56:59], s97 offen lds
    s_add_u32 m0, s25, 68608
    s_add_u32 s97, s73, 132096
    buffer_load_dwordx4 v10, s[56:59], s97 offen lds
    s_add_u32 s74, s72, 2
    s_and_b32 s74, s74, 15
    s_mul_i32 s74, s74, 81920
    s_add_u32 s74, s74, s26
    s_add_u32 m0, s27, 65536
    s_add_u32 s97, s74, 0
    buffer_load_dwordx4 v11, s[60:63], s97 offen lds
    s_add_u32 m0, s27, 66560
    s_add_u32 s97, s74, 5120
    buffer_load_dwordx4 v12, s[60:63], s97 offen lds
    s_add_u32 m0, s27, 67584
    s_add_u32 s97, s74, 10240
    buffer_load_dwordx4 v11, s[60:63], s97 offen lds
    s_add_u32 m0, s27, 68608
    s_add_u32 s97, s74, 15360
    buffer_load_dwordx4 v12, s[60:63], s97 offen lds
    s_waitcnt vmcnt(8)
    s_barrier
    s_add_u32 s73, s72, 3
    s_and_b32 s73, s73, 15
    s_lshl_b32 s73, s73, 11
    s_add_u32 s73, s73, s24
    s_add_u32 m0, s25, 98304
    s_add_u32 s97, s73, 0
    buffer_load_dwordx4 v10, s[56:59], s97 offen lds
    s_add_u32 m0, s25, 99328
    s_add_u32 s97, s73, 1024
    buffer_load_dwordx4 v10, s[56:59], s97 offen lds
    s_add_u32 m0, s25, 100352
    s_add_u32 s97, s73, 131072
    buffer_load_dwordx4 v10, s[56:59], s97 offen lds
    s_add_u32 m0, s25, 101376
    s_add_u32 s97, s73, 132096
    buffer_load_dwordx4 v10, s[56:59], s97 offen lds
    s_add_u32 s74, s72, 3
    s_and_b32 s74, s74, 15
    s_mul_i32 s74, s74, 81920
    s_add_u32 s74, s74, s26
    s_add_u32 m0, s27, 98304
    s_add_u32 s97, s74, 0
    buffer_load_dwordx4 v11, s[60:63], s97 offen lds
    s_add_u32 m0, s27, 99328
    s_add_u32 s97, s74, 5120
    buffer_load_dwordx4 v12, s[60:63], s97 offen lds
    s_add_u32 m0, s27, 100352
    s_add_u32 s97, s74, 10240
    buffer_load_dwordx4 v11, s[60:63], s97 offen lds
    s_add_u32 m0, s27, 101376
    s_add_u32 s97, s74, 15360
    buffer_load_dwordx4 v12, s[60:63], s97 offen lds
    s_waitcnt vmcnt(8)
    s_barrier
    s_add_u32 s73, s72, 4
    s_and_b32 s73, s73, 15
    s_lshl_b32 s73, s73, 11
    s_add_u32 s73, s73, s24
    s_add_u32 m0, s25, 131072
    s_add_u32 s97, s73, 0
    buffer_load_dwordx4 v10, s[56:59], s97 offen lds
    s_add_u32 m0, s25, 132096
    s_add_u32 s97, s73, 1024
    buffer_load_dwordx4 v10, s[56:59], s97 offen lds
    s_add_u32 m0, s25, 133120
    s_add_u32 s97, s73, 131072
    buffer_load_dwordx4 v10, s[56:59], s97 offen lds
    s_add_u32 m0, s25, 134144
    s_add_u32 s97, s73, 132096
    buffer_load_dwordx4 v10, s[56:59], s97 offen lds
    s_add_u32 s74, s72, 4
    s_and_b32 s74, s74, 15
    s_mul_i32 s74, s74, 81920
    s_add_u32 s74, s74, s26
    s_add_u32 m0, s27, 131072
    s_add_u32 s97, s74, 0
    buffer_load_dwordx4 v11, s[60:63], s97 offen lds
    s_add_u32 m0, s27, 132096
    s_add_u32 s97, s74, 5120
    buffer_load_dwordx4 v12, s[60:63], s97 offen lds
    s_add_u32 m0, s27, 133120
    s_add_u32 s97, s74, 10240
    buffer_load_dwordx4 v11, s[60:63], s97 offen lds
    s_add_u32 m0, s27, 134144
    s_add_u32 s97, s74, 15360
    buffer_load_dwordx4 v12, s[60:63], s97 offen lds
    s_waitcnt vmcnt(8)
    s_barrier
    s_add_u32 s73, s72, 5
    s_and_b32 s73, s73, 15
    s_lshl_b32 s73, s73, 11
    s_add_u32 s73, s73, s24
    s_add_u32 m0, s25, 0
    s_add_u32 s97, s73, 0
    buffer_load_dwordx4 v10, s[56:59], s97 offen lds
    s_add_u32 m0, s25, 1024
    s_add_u32 s97, s73, 1024
    buffer_load_dwordx4 v10, s[56:59], s97 offen lds
    s_add_u32 m0, s25, 2048
    s_add_u32 s97, s73, 131072
    buffer_load_dwordx4 v10, s[56:59], s97 offen lds
    s_add_u32 m0, s25, 3072
    s_add_u32 s97, s73, 132096
    buffer_load_dwordx4 v10, s[56:59], s97 offen lds
    s_add_u32 s74, s72, 5
    s_and_b32 s74, s74, 15
    s_mul_i32 s74, s74, 81920
    s_add_u32 s74, s74, s26
    s_add_u32 m0, s27, 0
    s_add_u32 s97, s74, 0
    buffer_load_dwordx4 v11, s[60:63], s97 offen lds
    s_add_u32 m0, s27, 1024
    s_add_u32 s97, s74, 5120
    buffer_load_dwordx4 v12, s[60:63], s97 offen lds
    s_add_u32 m0, s27, 2048
    s_add_u32 s97, s74, 10240
    buffer_load_dwordx4 v11, s[60:63], s97 offen lds
    s_add_u32 m0, s27, 3072
    s_add_u32 s97, s74, 15360
    buffer_load_dwordx4 v12, s[60:63], s97 offen lds
    s_waitcnt vmcnt(8)
    s_barrier
    s_add_u32 s73, s72, 6
    s_and_b32 s73, s73, 15
    s_lshl_b32 s73, s73, 11
    s_add_u32 s73, s73, s24
    s_add_u32 m0, s25, 32768
    s_add_u32 s97, s73, 0
    buffer_load_dwordx4 v10, s[56:59], s97 offen lds
    s_add_u32 m0, s25, 33792
    s_add_u32 s97, s73, 1024
    buffer_load_dwordx4 v10, s[56:59], s97 offen lds
    s_add_u32 m0, s25, 34816
    s_add_u32 s97, s73, 131072
    buffer_load_dwordx4 v10, s[56:59], s97 offen lds
    s_add_u32 m0, s25, 35840
    s_add_u32 s97, s73, 132096
    buffer_load_dwordx4 v10, s[56:59], s97 offen lds
    s_add_u32 s74, s72, 6
    s_and_b32 s74, s74, 15
    s_mul_i32 s74, s74, 81920
    s_add_u32 s74, s74, s26
    s_add_u32 m0, s27, 32768
    s_add_u32 s97, s74, 0
    buffer_load_dwordx4 v11, s[60:63], s97 offen lds
    s_add_u32 m0, s27, 33792
    s_add_u32 s97, s74, 5120
    buffer_load_dwordx4 v12, s[60:63], s97 offen lds
    s_add_u32 m0, s27, 34816
    s_add_u32 s97, s74, 10240
    buffer_load_dwordx4 v11, s[60:63], s97 offen lds
    s_add_u32 m0, s27, 35840
    s_add_u32 s97, s74, 15360
    buffer_load_dwordx4 v12, s[60:63], s97 offen lds
    s_waitcnt vmcnt(8)
    s_barrier
    s_add_u32 s73, s72, 7
    s_and_b32 s73, s73, 15
    s_lshl_b32 s73, s73, 11
    s_add_u32 s73, s73, s24
    s_add_u32 m0, s25, 65536
    s_add_u32 s97, s73, 0
    buffer_load_dwordx4 v10, s[56:59], s97 offen lds
    s_add_u32 m0, s25, 66560
    s_add_u32 s97, s73, 1024
    buffer_load_dwordx4 v10, s[56:59], s97 offen lds
    s_add_u32 m0, s25, 67584
    s_add_u32 s97, s73, 131072
    buffer_load_dwordx4 v10, s[56:59], s97 offen lds
    s_add_u32 m0, s25, 68608
    s_add_u32 s97, s73, 132096
    buffer_load_dwordx4 v10, s[56:59], s97 offen lds
    s_add_u32 s74, s72, 7
    s_and_b32 s74, s74, 15
    s_mul_i32 s74, s74, 81920
    s_add_u32 s74, s74, s26
    s_add_u32 m0, s27, 65536
    s_add_u32 s97, s74, 0
    buffer_load_dwordx4 v11, s[60:63], s97 offen lds
    s_add_u32 m0, s27, 66560
    s_add_u32 s97, s74, 5120
    buffer_load_dwordx4 v12, s[60:63], s97 offen lds
    s_add_u32 m0, s27, 67584
    s_add_u32 s97, s74, 10240
    buffer_load_dwordx4 v11, s[60:63], s97 offen lds
    s_add_u32 m0, s27, 68608
    s_add_u32 s97, s74, 15360
    buffer_load_dwordx4 v12, s[60:63], s97 offen lds
    s_waitcnt vmcnt(8)
    s_barrier
    s_add_u32 s73, s72, 8
    s_and_b32 s73, s73, 15
    s_lshl_b32 s73, s73, 11
    s_add_u32 s73, s73, s24
    s_add_u32 m0, s25, 98304
    s_add_u32 s97, s73, 0
    buffer_load_dwordx4 v10, s[56:59], s97 offen lds
    s_add_u32 m0, s25, 99328
    s_add_u32 s97, s73, 1024
    buffer_load_dwordx4 v10, s[56:59], s97 offen lds
    s_add_u32 m0, s25, 100352
    s_add_u32 s97, s73, 131072
    buffer_load_dwordx4 v10, s[56:59], s97 offen lds
    s_add_u32 m0, s25, 101376
    s_add_u32 s97, s73, 132096
    buffer_load_dwordx4 v10, s[56:59], s97 offen lds
    s_add_u32 s74, s72, 8
    s_and_b32 s74, s74, 15
    s_mul_i32 s74, s74, 81920
    s_add_u32 s74, s74, s26
    s_add_u32 m0, s27, 98304
    s_add_u32 s97, s74, 0
    buffer_load_dwordx4 v11, s[60:63], s97 offen lds
    s_add_u32 m0, s27, 99328
    s_add_u32 s97, s74, 5120
    buffer_load_dwordx4 v12, s[60:63], s97 offen lds
    s_add_u32 m0, s27, 100352
    s_add_u32 s97, s74, 10240
    buffer_load_dwordx4 v11, s[60:63], s97 offen lds
    s_add_u32 m0, s27, 101376
    s_add_u32 s97, s74, 15360
    buffer_load_dwordx4 v12, s[60:63], s97 offen lds
    s_waitcnt vmcnt(8)
    s_barrier
    s_add_u32 s73, s72, 9
    s_and_b32 s73, s73, 15
    s_lshl_b32 s73, s73, 11
    s_add_u32 s73, s73, s24
    s_add_u32 m0, s25, 131072
    s_add_u32 s97, s73, 0
    buffer_load_dwordx4 v10, s[56:59], s97 offen lds
    s_add_u32 m0, s25, 132096
    s_add_u32 s97, s73, 1024
    buffer_load_dwordx4 v10, s[56:59], s97 offen lds
    s_add_u32 m0, s25, 133120
    s_add_u32 s97, s73, 131072
    buffer_load_dwordx4 v10, s[56:59], s97 offen lds
    s_add_u32 m0, s25, 134144
    s_add_u32 s97, s73, 132096
    buffer_load_dwordx4 v10, s[56:59], s97 offen lds
    s_add_u32 s74, s72, 9
    s_and_b32 s74, s74, 15
    s_mul_i32 s74, s74, 81920
    s_add_u32 s74, s74, s26
    s_add_u32 m0, s27, 131072
    s_add_u32 s97, s74, 0
    buffer_load_dwordx4 v11, s[60:63], s97 offen lds
    s_add_u32 m0, s27, 132096
    s_add_u32 s97, s74, 5120
    buffer_load_dwordx4 v12, s[60:63], s97 offen lds
    s_add_u32 m0, s27, 133120
    s_add_u32 s97, s74, 10240
    buffer_load_dwordx4 v11, s[60:63], s97 offen lds
    s_add_u32 m0, s27, 134144
    s_add_u32 s97, s74, 15360
    buffer_load_dwordx4 v12, s[60:63], s97 offen lds
    s_waitcnt vmcnt(8)
    s_barrier
    s_add_u32 s73, s72, 10
    s_and_b32 s73, s73, 15
    s_lshl_b32 s73, s73, 11
    s_add_u32 s73, s73, s24
    s_add_u32 m0, s25, 0
    s_add_u32 s97, s73, 0
    buffer_load_dwordx4 v10, s[56:59], s97 offen lds
    s_add_u32 m0, s25, 1024
    s_add_u32 s97, s73, 1024
    buffer_load_dwordx4 v10, s[56:59], s97 offen lds
    s_add_u32 m0, s25, 2048
    s_add_u32 s97, s73, 131072
    buffer_load_dwordx4 v10, s[56:59], s97 offen lds
    s_add_u32 m0, s25, 3072
    s_add_u32 s97, s73, 132096
    buffer_load_dwordx4 v10, s[56:59], s97 offen lds
    s_add_u32 s74, s72, 10
    s_and_b32 s74, s74, 15
    s_mul_i32 s74, s74, 81920
    s_add_u32 s74, s74, s26
    s_add_u32 m0, s27, 0
    s_add_u32 s97, s74, 0
    buffer_load_dwordx4 v11, s[60:63], s97 offen lds
    s_add_u32 m0, s27, 1024
    s_add_u32 s97, s74, 5120
    buffer_load_dwordx4 v12, s[60:63], s97 offen lds
    s_add_u32 m0, s27, 2048
    s_add_u32 s97, s74, 10240
    buffer_load_dwordx4 v11, s[60:63], s97 offen lds
    s_add_u32 m0, s27, 3072
    s_add_u32 s97, s74, 15360
    buffer_load_dwordx4 v12, s[60:63], s97 offen lds
    s_waitcnt vmcnt(8)
    s_barrier
    s_add_u32 s73, s72, 11
    s_and_b32 s73, s73, 15
    s_lshl_b32 s73, s73, 11
    s_add_u32 s73, s73, s24
    s_add_u32 m0, s25, 32768
    s_add_u32 s97, s73, 0
    buffer_load_dwordx4 v10, s[56:59], s97 offen lds
    s_add_u32 m0, s25, 33792
    s_add_u32 s97, s73, 1024
    buffer_load_dwordx4 v10, s[56:59], s97 offen lds
    s_add_u32 m0, s25, 34816
    s_add_u32 s97, s73, 131072
    buffer_load_dwordx4 v10, s[56:59], s97 offen lds
    s_add_u32 m0, s25, 35840
    s_add_u32 s97, s73, 132096
    buffer_load_dwordx4 v10, s[56:59], s97 offen lds
    s_add_u32 s74, s72, 11
    s_and_b32 s74, s74, 15
    s_mul_i32 s74, s74, 81920
    s_add_u32 s74, s74, s26
    s_add_u32 m0, s27, 32768
    s_add_u32 s97, s74, 0
    buffer_load_dwordx4 v11, s[60:63], s97 offen lds
    s_add_u32 m0, s27, 33792
    s_add_u32 s97, s74, 5120
    buffer_load_dwordx4 v12, s[60:63], s97 offen lds
    s_add_u32 m0, s27, 34816
    s_add_u32 s97, s74, 10240
    buffer_load_dwordx4 v11, s[60:63], s97 offen lds
    s_add_u32 m0, s27, 35840
    s_add_u32 s97, s74, 15360
    buffer_load_dwordx4 v12, s[60:63], s97 offen lds
    s_waitcnt vmcnt(8)
    s_barrier
    s_add_u32 s73, s72, 12
    s_and_b32 s73, s73, 15
    s_lshl_b32 s73, s73, 11
    s_add_u32 s73, s73, s24
    s_add_u32 m0, s25, 65536
    s_add_u32 s97, s73, 0
    buffer_load_dwordx4 v10, s[56:59], s97 offen lds
    s_add_u32 m0, s25, 66560
    s_add_u32 s97, s73, 1024
    buffer_load_dwordx4 v10, s[56:59], s97 offen lds
    s_add_u32 m0, s25, 67584
    s_add_u32 s97, s73, 131072
    buffer_load_dwordx4 v10, s[56:59], s97 offen lds
    s_add_u32 m0, s25, 68608
    s_add_u32 s97, s73, 132096
    buffer_load_dwordx4 v10, s[56:59], s97 offen lds
    s_add_u32 s74, s72, 12
    s_and_b32 s74, s74, 15
    s_mul_i32 s74, s74, 81920
    s_add_u32 s74, s74, s26
    s_add_u32 m0, s27, 65536
    s_add_u32 s97, s74, 0
    buffer_load_dwordx4 v11, s[60:63], s97 offen lds
    s_add_u32 m0, s27, 66560
    s_add_u32 s97, s74, 5120
    buffer_load_dwordx4 v12, s[60:63], s97 offen lds
    s_add_u32 m0, s27, 67584
    s_add_u32 s97, s74, 10240
    buffer_load_dwordx4 v11, s[60:63], s97 offen lds
    s_add_u32 m0, s27, 68608
    s_add_u32 s97, s74, 15360
    buffer_load_dwordx4 v12, s[60:63], s97 offen lds
    s_waitcnt vmcnt(8)
    s_barrier
    s_add_u32 s73, s72, 13
    s_and_b32 s73, s73, 15
    s_lshl_b32 s73, s73, 11
    s_add_u32 s73, s73, s24
    s_add_u32 m0, s25, 98304
    s_add_u32 s97, s73, 0
    buffer_load_dwordx4 v10, s[56:59], s97 offen lds
    s_add_u32 m0, s25, 99328
    s_add_u32 s97, s73, 1024
    buffer_load_dwordx4 v10, s[56:59], s97 offen lds
    s_add_u32 m0, s25, 100352
    s_add_u32 s97, s73, 131072
    buffer_load_dwordx4 v10, s[56:59], s97 offen lds
    s_add_u32 m0, s25, 101376
    s_add_u32 s97, s73, 132096
    buffer_load_dwordx4 v10, s[56:59], s97 offen lds
    s_add_u32 s74, s72, 13
    s_and_b32 s74, s74, 15
    s_mul_i32 s74, s74, 81920
    s_add_u32 s74, s74, s26
    s_add_u32 m0, s27, 98304
    s_add_u32 s97, s74, 0
    buffer_load_dwordx4 v11, s[60:63], s97 offen lds
    s_add_u32 m0, s27, 99328
    s_add_u32 s97, s74, 5120
    buffer_load_dwordx4 v12, s[60:63], s97 offen lds
    s_add_u32 m0, s27, 100352
    s_add_u32 s97, s74, 10240
    buffer_load_dwordx4 v11, s[60:63], s97 offen lds
    s_add_u32 m0, s27, 101376
    s_add_u32 s97, s74, 15360
    buffer_load_dwordx4 v12, s[60:63], s97 offen lds
    s_waitcnt vmcnt(8)
    s_barrier
    s_add_u32 s73, s72, 14
    s_and_b32 s73, s73, 15
    s_lshl_b32 s73, s73, 11
    s_add_u32 s73, s73, s24
    s_add_u32 m0, s25, 131072
    s_add_u32 s97, s73, 0
    buffer_load_dwordx4 v10, s[56:59], s97 offen lds
    s_add_u32 m0, s25, 132096
    s_add_u32 s97, s73, 1024
    buffer_load_dwordx4 v10, s[56:59], s97 offen lds
    s_add_u32 m0, s25, 133120
    s_add_u32 s97, s73, 131072
    buffer_load_dwordx4 v10, s[56:59], s97 offen lds
    s_add_u32 m0, s25, 134144
    s_add_u32 s97, s73, 132096
    buffer_load_dwordx4 v10, s[56:59], s97 offen lds
    s_add_u32 s74, s72, 14
    s_and_b32 s74, s74, 15
    s_mul_i32 s74, s74, 81920
    s_add_u32 s74, s74, s26
    s_add_u32 m0, s27, 131072
    s_add_u32 s97, s74, 0
    buffer_load_dwordx4 v11, s[60:63], s97 offen lds
    s_add_u32 m0, s27, 132096
    s_add_u32 s97, s74, 5120
    buffer_load_dwordx4 v12, s[60:63], s97 offen lds
    s_add_u32 m0, s27, 133120
    s_add_u32 s97, s74, 10240
    buffer_load_dwordx4 v11, s[60:63], s97 offen lds
    s_add_u32 m0, s27, 134144
    s_add_u32 s97, s74, 15360
    buffer_load_dwordx4 v12, s[60:63], s97 offen lds
    s_waitcnt vmcnt(8)
    s_barrier
    s_add_u32 s73, s72, 15
    s_and_b32 s73, s73, 15
    s_lshl_b32 s73, s73, 11
    s_add_u32 s73, s73, s24
    s_add_u32 m0, s25, 0
    s_add_u32 s97, s73, 0
    buffer_load_dwordx4 v10, s[56:59], s97 offen lds
    s_add_u32 m0, s25, 1024
    s_add_u32 s97, s73, 1024
    buffer_load_dwordx4 v10, s[56:59], s97 offen lds
    s_add_u32 m0, s25, 2048
    s_add_u32 s97, s73, 131072
    buffer_load_dwordx4 v10, s[56:59], s97 offen lds
    s_add_u32 m0, s25, 3072
    s_add_u32 s97, s73, 132096
    buffer_load_dwordx4 v10, s[56:59], s97 offen lds
    s_add_u32 s74, s72, 15
    s_and_b32 s74, s74, 15
    s_mul_i32 s74, s74, 81920
    s_add_u32 s74, s74, s26
    s_add_u32 m0, s27, 0
    s_add_u32 s97, s74, 0
    buffer_load_dwordx4 v11, s[60:63], s97 offen lds
    s_add_u32 m0, s27, 1024
    s_add_u32 s97, s74, 5120
    buffer_load_dwordx4 v12, s[60:63], s97 offen lds
    s_add_u32 m0, s27, 2048
    s_add_u32 s97, s74, 10240
    buffer_load_dwordx4 v11, s[60:63], s97 offen lds
    s_add_u32 m0, s27, 3072
    s_add_u32 s97, s74, 15360
    buffer_load_dwordx4 v12, s[60:63], s97 offen lds
    s_waitcnt vmcnt(8)
    s_barrier
    s_waitcnt vmcnt(0)
    s_barrier
    s_cmp_lg_u32 s79, 4
    s_cbranch_scc1 L_end_k2
    s_barrier
    v_mov_b32 v18, 1
    buffer_store_dword v18, v16, s[56:59], 0 offen sc1
    s_mov_b32 s76, 200000
L_poll2:
    buffer_load_dword v19, v17, s[56:59], 0 offen sc1
    s_waitcnt vmcnt(0)
    v_cmp_ne_u32 vcc, 1, v19
    s_nop 4
    s_cmp_eq_u64 vcc, 0
    s_cbranch_scc1 L_done2
    s_sleep 4
    s_sub_u32 s76, s76, 1
    s_cmp_lg_u32 s76, 0
    s_cbranch_scc1 L_poll2
L_done2:
    s_barrier
L_end_k2:
    s_endpgm
L_code_end:
.section .rodata,"a"
.p2align 6
.amdhsa_kernel k1_kernel
  .amdhsa_next_free_vgpr 256
  .amdhsa_next_free_sgpr 100
  .amdhsa_accum_offset 256
  .amdhsa_group_segment_fixed_size 0
  .amdhsa_kernarg_size 104
  .amdhsa_user_sgpr_count 2
  .amdhsa_user_sgpr_kernarg_segment_ptr 1
  .amdhsa_system_sgpr_workgroup_id_x 1
.end_amdhsa_kernel
.p2align 6
.amdhsa_kernel k2_kernel
  .amdhsa_next_free_vgpr 256
  .amdhsa_next_free_sgpr 100
  .amdhsa_accum_offset 256
  .amdhsa_group_segment_fixed_size 0
  .amdhsa_kernarg_size 104
  .amdhsa_user_sgpr_count 2
  .amdhsa_user_sgpr_kernarg_segment_ptr 1
  .amdhsa_system_sgpr_workgroup_id_x 1
.end_amdhsa_kernel
```
